```python
import torch

def _softmax(x, axis=-1):
    return torch.softmax(x, dim=axis)
def _gelu(x):
    return torch.nn.functional.gelu(x, approximate="tanh")
def _silu(x):
    return torch.nn.functional.silu(x)
def _sigmoid(x):
    return torch.sigmoid(x)
def _layernorm(x, axis=-1, eps=1e-5):
    m = x.mean(dim=axis, keepdim=True)
    v = x.var(dim=axis, keepdim=True, unbiased=False)
    return (x - m) / torch.sqrt(v + eps)
def _scatter_add(tgt, idx, src, axis=0):
    return tgt.clone().index_add_(axis, idx, src)
def _segment_sum(src, seg, n):
    out = torch.zeros((n,) + src.shape[1:], dtype=src.dtype)
    return out.index_add_(0, seg, src)
def _pad(x, pw):
    flat = tuple(v for pair in reversed(pw) for v in pair)
    return torch.nn.functional.pad(x, flat)

kernel_name = 'gated_mix__ssm_conv_s4__ssm_conv_s4d__prompt'

def setup_inputs():

    _w = (lambda a: (lambda t: t.to(torch.bfloat16) if t.is_floating_point() else t)(torch.as_tensor(a)))
    def _A_setup():
        B, L, D, N = 1, 2048, 640, 192
        A_re = -(lambda _x: torch.exp(torch.as_tensor(_x)))((lambda *s: torch.randn(*s, dtype=torch.bfloat16) * 6.4)(D, N))
        A_im = torch.pi * (lambda *s: torch.randn(*s, dtype=torch.bfloat16) * 0.05)(D, N)
        B_re = (lambda *s: torch.randn(*s, dtype=torch.bfloat16) * 0.05)(D, N)
        B_im = (lambda *s: torch.randn(*s, dtype=torch.bfloat16) * 0.05)(D, N)
        C_re = (lambda *s: torch.randn(*s, dtype=torch.bfloat16) * 0.05)(D, N)
        C_im = (lambda *s: torch.randn(*s, dtype=torch.bfloat16) * 0.05)(D, N)
        log_dt = (lambda *s: torch.randn(*s, dtype=torch.bfloat16) * 0.05)(D) * 0.5 - 4.0
        Dskip = (lambda *s: torch.randn(*s, dtype=torch.bfloat16) * 0.05)(D)
        return {
            "u": _w((lambda *s: torch.randn(*s, dtype=torch.bfloat16) * 0.05)(B, L, D)),
            "A_re": _w(A_re),
            "A_im": _w(A_im),
            "B_re": _w(B_re),
            "B_im": _w(B_im),
            "C_re": _w(C_re),
            "C_im": _w(C_im),
            "log_dt": _w(log_dt),
            "Dskip": _w(Dskip),
        }
    _A_in = _A_setup()

    def _B_setup():
        Bsz, L, D, N = 1, 2048, 640, 192
        return {
            "u": _w((lambda *s: torch.randn(*s, dtype=torch.bfloat16) * 0.05)(Bsz, L, D)),
            "log_A_real": _w((lambda *s: torch.randn(*s, dtype=torch.bfloat16) * 6.4)(D, N) * 0.5),
            "A_imag": _w((lambda *s: torch.randn(*s, dtype=torch.bfloat16) * 0.05)(D, N) * 3.14),
            "C_real": _w((lambda *s: torch.randn(*s, dtype=torch.bfloat16) * 0.05)(D, N) / N ** 0.5),
            "C_imag": _w((lambda *s: torch.randn(*s, dtype=torch.bfloat16) * 0.05)(D, N) / N ** 0.5),
            "log_dt": _w((lambda *s: torch.randn(*s, dtype=torch.bfloat16) * 0.05)(D) * 0.5 - 4.0),
            "D_skip": _w((lambda *s: torch.randn(*s, dtype=torch.bfloat16) * 0.05)(D)),
        }
    _B_in = _B_setup()

    return {
        "A_u": _A_in["u"],
        "A_A_re": _A_in["A_re"],
        "A_A_im": _A_in["A_im"],
        "A_B_re": _A_in["B_re"],
        "A_B_im": _A_in["B_im"],
        "A_C_re": _A_in["C_re"],
        "A_C_im": _A_in["C_im"],
        "A_log_dt": _A_in["log_dt"],
        "A_Dskip": _A_in["Dskip"],
        "B_u": _B_in["u"],
        "B_log_A_real": _B_in["log_A_real"],
        "B_A_imag": _B_in["A_imag"],
        "B_C_real": _B_in["C_real"],
        "B_C_imag": _B_in["C_imag"],
        "B_log_dt": _B_in["log_dt"],
        "B_D_skip": _B_in["D_skip"],
        "gate_w": _w((lambda *s: torch.randn(*s, dtype=torch.bfloat16) * 0.05)(640) * 16.0),
    }

def reference(A_u, A_A_re, A_A_im, A_B_re, A_B_im, A_C_re, A_C_im, A_log_dt, A_Dskip, B_u, B_log_A_real, B_A_imag, B_C_real, B_C_imag, B_log_dt, B_D_skip, gate_w):
    def _A_ref(u, A_re, A_im, B_re, B_im, C_re, C_im, log_dt, Dskip):
        Bsz, L, D = u.shape
        dt = torch.exp(log_dt)[:, None]
        A = A_re + 1j * A_im
        Bc = B_re + 1j * B_im
        Cc = C_re + 1j * C_im
        logdA = dt * A
        dB = dt * Bc
        l = (lambda x, dt: x.to(dt))(torch.arange(L), A_re.dtype)
        P = torch.exp(logdA[:, :, None] * l[None, None, :])
        K = torch.einsum("dn,dnl,dn->dl", Cc, P, dB).real
        L2 = 2 * L
        Kp = _pad(K, ((0, 0), (0, L)))
        up = (lambda x, *d: x.permute(*d))(u, 0, 2, 1)
        up = _pad(up, ((0, 0), (0, 0), (0, L)))
        Kf = (lambda x, axes=(-2,-1): torch.fft.rfft2(x.float(), dim=axes))(Kp[:, None, :], axes=(-2, -1))
        Uf = (lambda x, axes=(-2,-1): torch.fft.rfft2(x.float(), dim=axes))(up[:, :, None, :], axes=(-2, -1))
        Yf = Uf * Kf[None, :, :, :]
        y = (lambda x, s, axes=(-2,-1): torch.fft.irfft2(x, s=s, dim=axes).to(torch.bfloat16))(Yf, (1, L2), axes=(-2, -1))[:, :, 0, :L]
        y = (lambda x, *d: x.permute(*d))(y, 0, 2, 1) + u * Dskip[None, None, :]
        return y

    def _B_ref(u, log_A_real, A_imag, C_real, C_imag, log_dt, D_skip):
        L = u.shape[1]
        dt = torch.exp(log_dt)
        A = -torch.exp(log_A_real) + 1j * A_imag
        C = (C_real + 1j * C_imag) * dt[:, None]
        pos = (lambda x, dt: x.to(dt))(torch.arange(L), log_dt.dtype)
        P = torch.exp((A * dt[:, None])[:, :, None] * pos[None, None, :])
        K = 2.0 * torch.einsum("dn,dnl->dl", C, P).real
        L2 = 2 * L
        u_t = (lambda x, *d: x.permute(*d))(u, 0, 2, 1)
        Kf = (lambda x, *a, **k: torch.fft.rfft(x.float(), *a, **k))(K, L2)
        Uf = (lambda x, *a, **k: torch.fft.rfft(x.float(), *a, **k))(u_t, L2)
        y = (lambda x, *a, **k: torch.fft.irfft(x, *a, **k).to(torch.bfloat16))(Uf * Kf[None, :, :], L2)[:, :, :L]
        y = (lambda x, *d: x.permute(*d))(y, 0, 2, 1)
        return y + u * D_skip[None, None, :]

    x = A_u
    g = _sigmoid((x * gate_w).sum(-1, keepdims=True))
    a = _A_ref(x, A_A_re, A_A_im, A_B_re, A_B_im, A_C_re, A_C_im, A_log_dt, A_Dskip)
    b = _B_ref(x, B_log_A_real, B_A_imag, B_C_real, B_C_imag, B_log_dt, B_D_skip)
    return g * a + (1 - g) * b
```

```asm
; @launch grid=(256,1,1) block=(768,1,1) lds=139328
.amdgcn_target "amdgcn-amd-amdhsa--gfx950"
.text
.globl gated_mix__ssm_conv_s4__ssm_conv_s4d__prompt_kernel
.p2align 8
.type gated_mix__ssm_conv_s4__ssm_conv_s4d__prompt_kernel,@function
gated_mix__ssm_conv_s4__ssm_conv_s4d__prompt_kernel:
    s_load_dwordx16 s[16:31], s[0:1], 0
    s_load_dwordx16 s[32:47], s[0:1], 64
    s_load_dwordx8 s[48:55], s[0:1], 128
    s_cmp_ge_u32 s2, 256
    s_cbranch_scc1 END
    v_lshrrev_b32 v1, 6, v0
    v_and_b32 v0, 63, v0
    s_getpc_b64 s[4:5]
PF_BASE:
    v_readfirstlane_b32 s3, v1
    s_cmp_ge_u32 s3, 2
    s_cbranch_scc1 NOPF
    v_lshl_add_u32 v1, v1, 6, v0
    v_lshlrev_b32 v1, 7, v1
    v_min_u32 v1, KG_SLOW-PF_BASE, v1
    global_load_dword v165, v1, s[4:5]
NOPF:
    s_cmp_lt_u32 s2, 32
    s_cbranch_scc1 PRODUCER
    s_and_b32 s4, s2, 7
    s_lshr_b32 s5, s2, 3
    s_sub_u32 s5, s5, 4
    s_cmp_ge_u32 s5, 11
    s_cselect_b32 s12, 1, 0
    s_cmp_ge_u32 s5, 22
    s_cselect_b32 s12, 2, s12
    s_cselect_b32 s13, 13, 29
    s_cselect_b32 s14, -64, 16
    s_mul_i32 s15, s12, 11
    s_sub_u32 s15, s5, s15
    s_mul_i32 s15, s15, 3
    s_min_u32 s15, s15, s13
    s_lshl_b32 s12, s12, 5
    s_add_u32 s15, s15, s12
    s_bitcmp1_b32 s4, 0
    s_cselect_b32 s14, s14, 0
    s_add_u32 s15, s15, s14
    s_mul_i32 s6, s4, 80
    s_add_u32 s6, s6, s15
    s_and_b32 s7, s3, 3
    s_cmp_eq_u32 s3, 10
    s_cbranch_scc1 LOADER
    s_lshl_b32 s12, s3, 1
    s_lshr_b32 s9, 0x266424, s12
    s_and_b32 s9, s9, 3
    s_lshr_b32 s11, 0xf88, s3
    s_and_b32 s11, s11, 1
    s_add_u32 s12, s6, s9
    s_lshl_b32 s13, s12, 1
    s_mul_i32 s12, s12, 384
    s_lshl_b32 s14, s11, 8
    s_add_u32 s12, s12, s14
    v_lshl_add_u32 v1, v0, 1, s12
    v_mov_b32 v46, s13
    v_mov_b32 v2, 0
    v_mov_b32 v3, 0
    v_mov_b32 v4, 0
    v_mov_b32 v5, 0
    v_mov_b32 v6, 0
    v_mov_b32 v7, 0
    v_mov_b32 v8, 0
    v_mov_b32 v9, 0
    v_mov_b32 v10, 0
    v_mov_b32 v11, 0
    v_mov_b32 v12, 0
    v_mov_b32 v13, 0
    v_mov_b32 v14, 0
    v_mov_b32 v166, 0
    s_lshr_b32 s10, 0xa70, s3
    s_and_b32 s10, s10, 1
    s_waitcnt lgkmcnt(0)
    s_cselect_b64 s[64:65], s[36:37], s[18:19]
    s_cselect_b64 s[66:67], s[38:39], s[20:21]
    s_cselect_b64 s[68:69], s[40:41], s[26:27]
    s_cselect_b64 s[70:71], s[42:43], s[28:29]
    s_cselect_b64 s[72:73], s[44:45], s[30:31]
    s_cselect_b64 s[74:75], s[46:47], s[32:33]
    global_load_short_d16_hi v14, v46, s[72:73]
    global_load_short_d16_hi v2, v1, s[64:65]
    global_load_short_d16_hi v3, v1, s[66:67]
    global_load_short_d16_hi v4, v1, s[68:69]
    global_load_short_d16_hi v5, v1, s[70:71]
    s_cbranch_scc1 NOB0
    global_load_short_d16_hi v6, v1, s[22:23]
    global_load_short_d16_hi v7, v1, s[24:25]
NOB0:
    s_cmp_eq_u32 s11, 1
    s_cbranch_scc1 LOADT
    global_load_short_d16_hi v8, v1, s[64:65] offset:128
    global_load_short_d16_hi v9, v1, s[66:67] offset:128
    global_load_short_d16_hi v10, v1, s[68:69] offset:128
    global_load_short_d16_hi v11, v1, s[70:71] offset:128
    global_load_short_d16_hi v166, v46, s[74:75]
    s_cmp_eq_u32 s10, 1
    s_cbranch_scc1 LOADED
    global_load_short_d16_hi v12, v1, s[22:23] offset:128
    global_load_short_d16_hi v13, v1, s[24:25] offset:128
    s_branch LOADED
LOADT:
    s_cmp_lg_u32 s3, 3
    s_cbranch_scc1 LOADED
    global_load_short_d16_hi v8, v1, s[36:37] offset:768
    global_load_short_d16_hi v9, v1, s[38:39] offset:768
    global_load_short_d16_hi v10, v1, s[40:41] offset:768
    global_load_short_d16_hi v11, v1, s[42:43] offset:768
    global_load_short_d16_hi v12, v46, s[44:45] offset:4
LOADED:
    s_barrier
    s_branch WORKER
LOADER:
    s_lshl_b32 s12, s5, 5
    v_lshrrev_b32 v3, 1, v0
    v_add_u32 v3, s12, v3
    v_mul_u32_u24 v3, 1280, v3
    v_and_b32 v4, 1, v0
    v_mul_u32_u24 v4, 156, v4
    s_mul_i32 s12, s4, 160
    v_add3_u32 v3, v3, v4, s12
    v_add_u32 v4, 1146880, v3
    v_add_u32 v5, 2293760, v3
    v_and_b32 v2, 15, v0
    v_lshlrev_b32 v2, 2, v2
    v_add_u32 v2, 131072, v2
    v_mov_b32 v8, 0
    ds_write_b32 v2, v8
    s_lshl_b32 s9, s6, 1
    s_and_b32 s9, s9, -4
    v_mul_u32_u24 v1, 5120, v0
    v_add_u32 v1, s9, v1
    s_mov_b32 s4, 0
    s_setprio 2
    s_waitcnt lgkmcnt(0)
    s_mov_b32 s56, s16
    s_mov_b32 s57, s17
    s_mov_b32 s58, 2621440
    s_mov_b32 s59, 0x20000
    s_barrier
    s_sleep 20
    buffer_load_dword v60, v3, s[56:59], 0 offen
    buffer_load_dword v61, v4, s[56:59], 0 offen
    buffer_load_dword v62, v5, s[56:59], 0 offen
    buffer_load_dwordx2 v[12:13], v1, s[56:59], s4 offen offset:0
    buffer_load_dwordx2 v[14:15], v1, s[56:59], s4 offen offset:1280
    buffer_load_dwordx2 v[16:17], v1, s[56:59], s4 offen offset:2560
    buffer_load_dwordx2 v[18:19], v1, s[56:59], s4 offen offset:3840
    s_add_u32 s4, s4, 327680
    buffer_load_dwordx2 v[20:21], v1, s[56:59], s4 offen offset:0
    buffer_load_dwordx2 v[22:23], v1, s[56:59], s4 offen offset:1280
    buffer_load_dwordx2 v[24:25], v1, s[56:59], s4 offen offset:2560
    buffer_load_dwordx2 v[26:27], v1, s[56:59], s4 offen offset:3840
    s_add_u32 s4, s4, 327680
    v_lshlrev_b32 v6, 21, v0
    s_mov_b64 exec, 3
    global_load_dword v63, v6, s[50:51]
    s_mov_b64 exec, -1
    v_mov_b32 v9, 0
    v_mov_b32 v10, 0
    v_mov_b32 v11, 0
    v_lshrrev_b32 v2, 5, v0
    v_mul_u32_u24 v2, 4608, v2
    v_and_b32 v3, 31, v0
    v_lshl_add_u32 v2, v3, 4, v2
    v_add_u32 v2, 98816, v2
    ds_write_b128 v2, v[8:11]
    ds_write_b128 v2, v[8:11] offset:4608
    v_lshlrev_b32 v3, 2, v3
    v_lshlrev_b32 v2, 3, v0
    v_add_u32 v2, 99328, v2
    v_mov_b32 v47, 131112
    s_mov_b32 s13, 0x05040100
    s_mov_b32 s14, 0x07060302
    s_and_b32 s12, s6, 1
    s_mul_i32 s12, s12, 4608
    v_lshl_add_u32 v7, s12, 1, v2
    v_subrev_u32 v2, s12, v2
    v_lshlrev_b32 v4, 4, v0
    v_add_u32 v5, 4096, v4
    v_add_u32 v45, 131136, v4
    s_waitcnt vmcnt(5)
    s_bitcmp1_b32 s6, 0
    v_perm_b32 v30, v14, v12, s14
    v_perm_b32 v32, v15, v13, s13
    v_perm_b32 v31, v18, v16, s14
    v_perm_b32 v33, v19, v17, s13
    s_cbranch_scc1 LO0
    v_perm_b32 v28, v14, v12, s13
    v_perm_b32 v29, v18, v16, s13
    s_branch LE0
LO0:
    v_perm_b32 v28, v15, v13, s14
    v_perm_b32 v29, v19, v17, s14
LE0:
    buffer_load_dwordx2 v[12:13], v1, s[56:59], s4 offen offset:0
    buffer_load_dwordx2 v[14:15], v1, s[56:59], s4 offen offset:1280
    buffer_load_dwordx2 v[16:17], v1, s[56:59], s4 offen offset:2560
    buffer_load_dwordx2 v[18:19], v1, s[56:59], s4 offen offset:3840
    s_add_u32 s4, s4, 327680
    ds_write_b64 v7, v[28:29] offset:0
    ds_write_b64 v2, v[30:31] offset:4608
    ds_write_b64 v2, v[32:33] offset:9216
    s_waitcnt vmcnt(5)
    s_bitcmp1_b32 s6, 0
    v_perm_b32 v30, v22, v20, s14
    v_perm_b32 v32, v23, v21, s13
    v_perm_b32 v31, v26, v24, s14
    v_perm_b32 v33, v27, v25, s13
    s_cbranch_scc1 LO1
    v_perm_b32 v28, v22, v20, s13
    v_perm_b32 v29, v26, v24, s13
    s_branch LE1
LO1:
    v_perm_b32 v28, v23, v21, s14
    v_perm_b32 v29, v27, v25, s14
LE1:
    buffer_load_dwordx2 v[20:21], v1, s[56:59], s4 offen offset:0
    buffer_load_dwordx2 v[22:23], v1, s[56:59], s4 offen offset:1280
    buffer_load_dwordx2 v[24:25], v1, s[56:59], s4 offen offset:2560
    buffer_load_dwordx2 v[26:27], v1, s[56:59], s4 offen offset:3840
    s_add_u32 s4, s4, 327680
    ds_write_b64 v7, v[28:29] offset:512
    ds_write_b64 v2, v[30:31] offset:5120
    ds_write_b64 v2, v[32:33] offset:9728
    v_mov_b32 v8, 2
    ds_write_b32 v47, v8
    s_waitcnt vmcnt(4)
    s_bitcmp1_b32 s6, 0
    v_perm_b32 v30, v14, v12, s14
    v_perm_b32 v32, v15, v13, s13
    v_perm_b32 v31, v18, v16, s14
    v_perm_b32 v33, v19, v17, s13
    s_cbranch_scc1 LO2
    v_perm_b32 v28, v14, v12, s13
    v_perm_b32 v29, v18, v16, s13
    s_branch LE2
LO2:
    v_perm_b32 v28, v15, v13, s14
    v_perm_b32 v29, v19, v17, s14
LE2:
    global_load_dword v9, v3, s[52:53] sc0 sc1
    buffer_load_dwordx2 v[12:13], v1, s[56:59], s4 offen offset:0
    buffer_load_dwordx2 v[14:15], v1, s[56:59], s4 offen offset:1280
    buffer_load_dwordx2 v[16:17], v1, s[56:59], s4 offen offset:2560
    buffer_load_dwordx2 v[18:19], v1, s[56:59], s4 offen offset:3840
    s_add_u32 s4, s4, 327680
    ds_write_b64 v7, v[28:29] offset:1024
    ds_write_b64 v2, v[30:31] offset:5632
    ds_write_b64 v2, v[32:33] offset:10240
    v_mov_b32 v8, 6
    ds_write_b32 v47, v8
    s_waitcnt vmcnt(5)
    s_bitcmp1_b32 s6, 0
    v_perm_b32 v30, v22, v20, s14
    v_perm_b32 v32, v23, v21, s13
    v_perm_b32 v31, v26, v24, s14
    v_perm_b32 v33, v27, v25, s13
    s_cbranch_scc1 LO3
    v_perm_b32 v28, v22, v20, s13
    v_perm_b32 v29, v26, v24, s13
    s_branch LE3
LO3:
    v_perm_b32 v28, v23, v21, s14
    v_perm_b32 v29, v27, v25, s14
LE3:
    buffer_load_dwordx2 v[20:21], v1, s[56:59], s4 offen offset:0
    buffer_load_dwordx2 v[22:23], v1, s[56:59], s4 offen offset:1280
    buffer_load_dwordx2 v[24:25], v1, s[56:59], s4 offen offset:2560
    buffer_load_dwordx2 v[26:27], v1, s[56:59], s4 offen offset:3840
    s_add_u32 s4, s4, 327680
    ds_write_b64 v7, v[28:29] offset:1536
    ds_write_b64 v2, v[30:31] offset:6144
    ds_write_b64 v2, v[32:33] offset:10752
    v_mov_b32 v8, 7
    ds_write_b32 v47, v8
    s_waitcnt vmcnt(4)
    s_bitcmp1_b32 s6, 0
    v_perm_b32 v30, v14, v12, s14
    v_perm_b32 v32, v15, v13, s13
    v_perm_b32 v31, v18, v16, s14
    v_perm_b32 v33, v19, v17, s13
    s_cbranch_scc1 LO4
    v_perm_b32 v28, v14, v12, s13
    v_perm_b32 v29, v18, v16, s13
    s_branch LE4
LO4:
    v_perm_b32 v28, v15, v13, s14
    v_perm_b32 v29, v19, v17, s14
LE4:
    v_cmp_eq_u32 s[10:11], 0, v9
    global_load_dwordx4 v[64:67], v4, s[54:55] offset:0 sc0 sc1
    global_load_dwordx4 v[68:71], v4, s[54:55] offset:1024 sc0 sc1
    global_load_dwordx4 v[72:75], v4, s[54:55] offset:2048 sc0 sc1
    global_load_dwordx4 v[76:79], v4, s[54:55] offset:3072 sc0 sc1
    global_load_dwordx4 v[80:83], v5, s[54:55] offset:0 sc0 sc1
    global_load_dwordx4 v[84:87], v5, s[54:55] offset:1024 sc0 sc1
    global_load_dwordx4 v[88:91], v5, s[54:55] offset:2048 sc0 sc1
    global_load_dwordx4 v[92:95], v5, s[54:55] offset:3072 sc0 sc1
    buffer_load_dwordx2 v[12:13], v1, s[56:59], s4 offen offset:0
    buffer_load_dwordx2 v[14:15], v1, s[56:59], s4 offen offset:1280
    buffer_load_dwordx2 v[16:17], v1, s[56:59], s4 offen offset:2560
    buffer_load_dwordx2 v[18:19], v1, s[56:59], s4 offen offset:3840
    s_add_u32 s4, s4, 327680
    ds_write_b64 v7, v[28:29] offset:2048
    ds_write_b64 v2, v[30:31] offset:6656
    ds_write_b64 v2, v[32:33] offset:11264
    s_waitcnt vmcnt(12)
    s_bitcmp1_b32 s6, 0
    v_perm_b32 v30, v22, v20, s14
    v_perm_b32 v32, v23, v21, s13
    v_perm_b32 v31, v26, v24, s14
    v_perm_b32 v33, v27, v25, s13
    s_cbranch_scc1 LO5
    v_perm_b32 v28, v22, v20, s13
    v_perm_b32 v29, v26, v24, s13
    s_branch LE5
LO5:
    v_perm_b32 v28, v23, v21, s14
    v_perm_b32 v29, v27, v25, s14
LE5:
    buffer_load_dwordx2 v[20:21], v1, s[56:59], s4 offen offset:0
    buffer_load_dwordx2 v[22:23], v1, s[56:59], s4 offen offset:1280
    buffer_load_dwordx2 v[24:25], v1, s[56:59], s4 offen offset:2560
    buffer_load_dwordx2 v[26:27], v1, s[56:59], s4 offen offset:3840
    s_add_u32 s4, s4, 327680
    ds_write_b64 v7, v[28:29] offset:2560
    ds_write_b64 v2, v[30:31] offset:7168
    ds_write_b64 v2, v[32:33] offset:11776
    v_mov_b32 v8, 8
    ds_write_b32 v47, v8
    s_waitcnt vmcnt(8)
    v_max_u32 v6, v64, v65
    v_max3_u32 v6, v6, v66, v67
    v_max3_u32 v6, v6, v68, v69
    v_max3_u32 v6, v6, v70, v71
    v_max3_u32 v6, v6, v72, v73
    v_max3_u32 v6, v6, v74, v75
    v_max3_u32 v6, v6, v76, v77
    v_max3_u32 v6, v6, v78, v79
    v_max3_u32 v6, v6, v80, v81
    v_max3_u32 v6, v6, v82, v83
    v_max3_u32 v6, v6, v84, v85
    v_max3_u32 v6, v6, v86, v87
    v_max3_u32 v6, v6, v88, v89
    v_max3_u32 v6, v6, v90, v91
    v_max3_u32 v6, v6, v92, v93
    v_max3_u32 v6, v6, v94, v95
    v_cmp_eq_u32 vcc, -1, v6
    s_or_b64 s[10:11], s[10:11], vcc
    s_cbranch_scc1 GNOT
    ds_write_b128 v45, v[64:67] offset:0
    ds_write_b128 v45, v[68:71] offset:1024
    ds_write_b128 v45, v[72:75] offset:2048
    ds_write_b128 v45, v[76:79] offset:3072
    ds_write_b128 v45, v[80:83] offset:4096
    ds_write_b128 v45, v[84:87] offset:5120
    ds_write_b128 v45, v[88:91] offset:6144
    ds_write_b128 v45, v[92:95] offset:7168
    v_mov_b32 v6, 9
    ds_write_b32 v47, v6 offset:12
GNOT:
    s_waitcnt vmcnt(4)
    s_bitcmp1_b32 s6, 0
    v_perm_b32 v30, v14, v12, s14
    v_perm_b32 v32, v15, v13, s13
    v_perm_b32 v31, v18, v16, s14
    v_perm_b32 v33, v19, v17, s13
    s_cbranch_scc1 LO6
    v_perm_b32 v28, v14, v12, s13
    v_perm_b32 v29, v18, v16, s13
    s_branch LE6
LO6:
    v_perm_b32 v28, v15, v13, s14
    v_perm_b32 v29, v19, v17, s14
LE6:
    ds_write_b64 v7, v[28:29] offset:3072
    ds_write_b64 v2, v[30:31] offset:7680
    ds_write_b64 v2, v[32:33] offset:12288
    s_waitcnt vmcnt(0)
    s_bitcmp1_b32 s6, 0
    v_perm_b32 v30, v22, v20, s14
    v_perm_b32 v32, v23, v21, s13
    v_perm_b32 v31, v26, v24, s14
    v_perm_b32 v33, v27, v25, s13
    s_cbranch_scc1 LO7
    v_perm_b32 v28, v22, v20, s13
    v_perm_b32 v29, v26, v24, s13
    s_branch LE7
LO7:
    v_perm_b32 v28, v23, v21, s14
    v_perm_b32 v29, v27, v25, s14
LE7:
    ds_write_b64 v7, v[28:29] offset:3584
    ds_write_b64 v2, v[30:31] offset:8192
    ds_write_b64 v2, v[32:33] offset:12800
    v_mov_b32 v8, 9
    ds_write_b32 v47, v8
    s_cmp_eq_u64 s[10:11], 0
    s_cbranch_scc1 HELPER
    s_mov_b32 s1, 0
GPOLL:
    global_load_dword v9, v3, s[52:53] sc0 sc1
    s_waitcnt vmcnt(0)
    v_cmp_eq_u32 vcc, 0, v9
    s_cbranch_vccnz GAGAIN
    global_load_dwordx4 v[64:67], v4, s[54:55] offset:0 sc0 sc1
    global_load_dwordx4 v[68:71], v4, s[54:55] offset:1024 sc0 sc1
    global_load_dwordx4 v[72:75], v4, s[54:55] offset:2048 sc0 sc1
    global_load_dwordx4 v[76:79], v4, s[54:55] offset:3072 sc0 sc1
    global_load_dwordx4 v[80:83], v5, s[54:55] offset:0 sc0 sc1
    global_load_dwordx4 v[84:87], v5, s[54:55] offset:1024 sc0 sc1
    global_load_dwordx4 v[88:91], v5, s[54:55] offset:2048 sc0 sc1
    global_load_dwordx4 v[92:95], v5, s[54:55] offset:3072 sc0 sc1
    s_waitcnt vmcnt(0)
    v_max_u32 v6, v64, v65
    v_max3_u32 v6, v6, v66, v67
    v_max3_u32 v6, v6, v68, v69
    v_max3_u32 v6, v6, v70, v71
    v_max3_u32 v6, v6, v72, v73
    v_max3_u32 v6, v6, v74, v75
    v_max3_u32 v6, v6, v76, v77
    v_max3_u32 v6, v6, v78, v79
    v_max3_u32 v6, v6, v80, v81
    v_max3_u32 v6, v6, v82, v83
    v_max3_u32 v6, v6, v84, v85
    v_max3_u32 v6, v6, v86, v87
    v_max3_u32 v6, v6, v88, v89
    v_max3_u32 v6, v6, v90, v91
    v_max3_u32 v6, v6, v92, v93
    v_max3_u32 v6, v6, v94, v95
    v_cmp_eq_u32 vcc, -1, v6
    s_cbranch_vccz GOK
GAGAIN:
    s_sleep 4
    s_add_u32 s1, s1, 1
    s_cmp_lt_u32 s1, 0x4000
    s_cbranch_scc1 GPOLL
GOK:
    ds_write_b128 v45, v[64:67] offset:0
    ds_write_b128 v45, v[68:71] offset:1024
    ds_write_b128 v45, v[72:75] offset:2048
    ds_write_b128 v45, v[76:79] offset:3072
    ds_write_b128 v45, v[80:83] offset:4096
    ds_write_b128 v45, v[84:87] offset:5120
    ds_write_b128 v45, v[88:91] offset:6144
    ds_write_b128 v45, v[92:95] offset:7168
    v_mov_b32 v6, 9
    ds_write_b32 v47, v6 offset:12
    s_branch HELPER
PRODUCER:
    s_cmp_gt_u32 s3, 9
    s_cbranch_scc1 END
    s_lshl_b32 s4, s2, 5
    s_cmp_ge_u32 s3, 8
    s_cbranch_scc1 PCLEAR
    v_lshrrev_b32 v1, 3, v0
    v_lshrrev_b32 v2, 5, v0
    v_and_b32 v3, 3, v1
    v_lshl_add_u32 v2, v2, 4, v3
    s_and_b32 s5, s2, 7
    s_lshl_b32 s5, s5, 5
    s_lshr_b32 s6, s2, 3
    s_lshl_b32 s6, s6, 2
    s_add_u32 s5, s5, s6
    s_lshl_b32 s6, s3, 8
    s_add_u32 s5, s5, s6
    v_add_u32 v2, s5, v2
    v_mul_u32_u24 v2, 1280, v2
    v_and_b32 v3, 7, v0
    v_lshlrev_b32 v3, 4, v3
    v_add_u32 v2, v2, v3
    s_lshl_b32 s6, s3, 10
    s_add_u32 s4, s4, s6
    v_lshl_add_u32 v1, v1, 2, s4
    s_barrier
    s_waitcnt lgkmcnt(0)
    v_and_b32 v90, 1, v0
    v_lshlrev_b32 v90, 2, v90
    s_cmp_lt_u32 s3, 4
    s_cbranch_scc1 PGO
    s_mov_b32 s1, 0
POLL_1:
    ds_read_b32 v91, v90
    s_waitcnt lgkmcnt(0)
    v_cmp_le_u32 vcc, 1, v91
    s_andn2_b32 s12, 1, vcc_lo
    s_cbranch_scc0 POLL_1_X
    s_sleep 2
    s_add_u32 s1, s1, 1
    s_cmp_lt_u32 s1, 0x8000
    s_cbranch_scc1 POLL_1
POLL_1_X:
PGO:
    global_load_dwordx4 v[8:11], v2, s[16:17] offset:0
    global_load_dwordx4 v[12:15], v2, s[16:17] offset:128
    global_load_dwordx4 v[16:19], v2, s[16:17] offset:256
    global_load_dwordx4 v[20:23], v2, s[16:17] offset:384
    global_load_dwordx4 v[24:27], v2, s[16:17] offset:512
    global_load_dwordx4 v[28:31], v2, s[16:17] offset:640
    global_load_dwordx4 v[32:35], v2, s[16:17] offset:768
    global_load_dwordx4 v[36:39], v2, s[16:17] offset:896
    global_load_dwordx4 v[40:43], v2, s[16:17] offset:1024
    global_load_dwordx4 v[44:47], v2, s[16:17] offset:1152
    s_mov_b32 s1, 0
POLL_2:
    ds_read_b32 v91, v90
    s_waitcnt lgkmcnt(0)
    v_cmp_le_u32 vcc, 1, v91
    s_andn2_b32 s12, 3, vcc_lo
    s_cbranch_scc0 POLL_2_X
    s_sleep 2
    s_add_u32 s1, s1, 1
    s_cmp_lt_u32 s1, 0x8000
    s_cbranch_scc1 POLL_2
POLL_2_X:
    ds_read_b128 v[48:51], v3 offset:64
    ds_read_b128 v[52:55], v3 offset:192
    ds_read_b128 v[56:59], v3 offset:320
    ds_read_b128 v[60:63], v3 offset:448
    ds_read_b128 v[64:67], v3 offset:576
    ds_read_b128 v[68:71], v3 offset:704
    ds_read_b128 v[72:75], v3 offset:832
    ds_read_b128 v[76:79], v3 offset:960
    ds_read_b128 v[80:83], v3 offset:1088
    ds_read_b128 v[84:87], v3 offset:1216
    s_waitcnt lgkmcnt(0)
    s_waitcnt vmcnt(9)
    v_dot2_f32_bf16 v4, v8, v48, 0
    v_dot2_f32_bf16 v5, v9, v49, 0
    v_dot2_f32_bf16 v6, v10, v50, 0
    v_dot2_f32_bf16 v7, v11, v51, 0
    s_waitcnt vmcnt(8)
    v_dot2_f32_bf16 v4, v12, v52, v4
    v_dot2_f32_bf16 v5, v13, v53, v5
    v_dot2_f32_bf16 v6, v14, v54, v6
    v_dot2_f32_bf16 v7, v15, v55, v7
    s_waitcnt vmcnt(7)
    v_dot2_f32_bf16 v4, v16, v56, v4
    v_dot2_f32_bf16 v5, v17, v57, v5
    v_dot2_f32_bf16 v6, v18, v58, v6
    v_dot2_f32_bf16 v7, v19, v59, v7
    s_waitcnt vmcnt(6)
    v_dot2_f32_bf16 v4, v20, v60, v4
    v_dot2_f32_bf16 v5, v21, v61, v5
    v_dot2_f32_bf16 v6, v22, v62, v6
    v_dot2_f32_bf16 v7, v23, v63, v7
    s_waitcnt vmcnt(5)
    v_dot2_f32_bf16 v4, v24, v64, v4
    v_dot2_f32_bf16 v5, v25, v65, v5
    v_dot2_f32_bf16 v6, v26, v66, v6
    v_dot2_f32_bf16 v7, v27, v67, v7
    s_waitcnt vmcnt(4)
    v_dot2_f32_bf16 v4, v28, v68, v4
    v_dot2_f32_bf16 v5, v29, v69, v5
    v_dot2_f32_bf16 v6, v30, v70, v6
    v_dot2_f32_bf16 v7, v31, v71, v7
    s_waitcnt vmcnt(3)
    v_dot2_f32_bf16 v4, v32, v72, v4
    v_dot2_f32_bf16 v5, v33, v73, v5
    v_dot2_f32_bf16 v6, v34, v74, v6
    v_dot2_f32_bf16 v7, v35, v75, v7
    s_waitcnt vmcnt(2)
    v_dot2_f32_bf16 v4, v36, v76, v4
    v_dot2_f32_bf16 v5, v37, v77, v5
    v_dot2_f32_bf16 v6, v38, v78, v6
    v_dot2_f32_bf16 v7, v39, v79, v7
    s_waitcnt vmcnt(1)
    v_dot2_f32_bf16 v4, v40, v80, v4
    v_dot2_f32_bf16 v5, v41, v81, v5
    v_dot2_f32_bf16 v6, v42, v82, v6
    v_dot2_f32_bf16 v7, v43, v83, v7
    s_waitcnt vmcnt(0)
    v_dot2_f32_bf16 v4, v44, v84, v4
    v_dot2_f32_bf16 v5, v45, v85, v5
    v_dot2_f32_bf16 v6, v46, v86, v6
    v_dot2_f32_bf16 v7, v47, v87, v7
    v_mov_b32 v8, 0
    s_nop 1
    v_add_f32 v4, v4, v5
    v_add_f32 v6, v6, v7
    v_add_f32 v4, v4, v6
    s_nop 1
    v_add_f32_dpp v4, v4, v4 quad_perm:[1,0,3,2] row_mask:0xf bank_mask:0xf
    s_nop 1
    v_add_f32_dpp v4, v4, v4 quad_perm:[2,3,0,1] row_mask:0xf bank_mask:0xf
    s_nop 1
    v_add_f32_dpp v4, v4, v4 row_half_mirror row_mask:0xf bank_mask:0xf
    v_cvt_pk_bf16_f32 v4, v4, v4
    v_and_b32 v4, 0xffff0000, v4
    v_mul_f32 v4, 0xbfb8aa3b, v4
    v_exp_f32 v4, v4
    s_nop 0
    v_add_f32 v4, 1.0, v4
    v_rcp_f32 v4, v4
    s_nop 0
    v_cvt_pk_bf16_f32 v4, v4, v4
    v_and_b32 v4, 0xffff0000, v4
    s_mov_b32 exec_lo, 0x01010101
    s_mov_b32 exec_hi, 0x01010101
    global_store_dword v1, v4, s[54:55] sc0 sc1
    s_branch FIN
PCLEAR:
    v_mov_b32 v4, 0
    v_mov_b32 v2, -1
    s_cmp_eq_u32 s3, 9
    s_cbranch_scc1 PGATE
    ds_write_b32 v4, v4
    v_lshrrev_b32 v1, 3, v0
    v_and_b32 v3, 7, v0
    v_lshlrev_b32 v1, 10, v1
    v_lshl_add_u32 v1, v3, 2, v1
    v_add_u32 v1, s4, v1
    s_lshl_b32 s4, s2, 2
    v_mov_b32 v3, s4
    s_waitcnt lgkmcnt(0)
    global_store_dword v1, v2, s[54:55] sc0 sc1
    s_barrier
    s_mov_b64 exec, 1
    s_waitcnt vmcnt(0)
    global_store_dword v3, v2, s[52:53] sc0 sc1
    ds_write_b32 v4, v2
    s_endpgm
PGATE:
    ds_write_b32 v4, v4 offset:4
    v_lshlrev_b32 v5, 2, v0
    v_lshlrev_b32 v6, 4, v0
    s_waitcnt lgkmcnt(0)
    global_load_dwordx4 v[8:11], v6, s[48:49]
    global_load_dword v12, v5, s[48:49] offset:1024
    global_load_dword v13, v4, s[52:53] offset:128
    s_barrier
    s_waitcnt vmcnt(0)
    ds_write_b128 v6, v[8:11] offset:64
    ds_write_b32 v5, v12 offset:1088
    ds_write_b32 v4, v2 offset:4
    s_endpgm
WORKER:
    s_lshr_b32 s8, s3, 2
    s_lshl_b32 s76, s3, 8
    s_add_u32 s77, s76, 33968
    s_mov_b32 m0, s76
    v_mov_b32 v40, 0x3c00
    ds_write_addtid_b32 v40
    v_and_b32 v44, 31, v0
    v_mul_u32_u24 v44, 3088, v44
    v_lshrrev_b32 v40, 5, v0
    v_lshl_add_u32 v44, v40, 4, v44
    v_add_u32 v44, s76, v44
    s_lshl_b32 s12, s3, 2
    s_add_u32 s12, s12, 131072
    v_mov_b32 v47, s12
    v_and_b32 v41, 15, v0
    v_lshlrev_b32 v46, 2, v41
    v_add_u32 v46, 131072, v46
    v_lshrrev_b32 v40, 4, v0
    v_mul_u32_u24 v45, 3088, v40
    v_lshl_add_u32 v45, v41, 4, v45
    v_mov_b32 v48, 0
    v_mov_b32 v49, 0
    v_mov_b32 v50, 0
    v_mov_b32 v51, 0
    v_mov_b32 v52, 0
    v_mov_b32 v53, 0
    v_mov_b32 v54, 0
    v_mov_b32 v55, 0
    v_mov_b32 v56, 0
    v_mov_b32 v57, 0
    v_mov_b32 v58, 0
    v_mov_b32 v59, 0
    v_mov_b32 v60, 0
    v_mov_b32 v61, 0
    v_mov_b32 v62, 0
    v_mov_b32 v63, 0
    s_cmp_eq_u32 s11, 1
    s_cbranch_scc1 PRE1
    s_lshl_b32 s12, s3, 2
    s_lshr_b32 s13, 0x39b087a, s12
    s_and_b32 s13, s13, 15
    s_lshl_b32 s13, s13, 8
    v_add_u32 v147, s13, v45
    s_lshr_b32 s13, 0x39b0873, s12
    s_and_b32 s13, s13, 15
    s_lshl_b32 s56, 1, s13
    s_cmp_eq_u32 s3, 6
    s_cselect_b32 s57, 2, 1
    s_lshl_b32 s13, s9, 1
    s_add_u32 s13, s13, s10
    s_mul_i32 s14, s13, 3072
    s_add_u32 s14, s14, 112640
    v_lshl_add_u32 v144, v0, 4, s14
    ds_write_b128 v144, v[48:51]
    ds_write_b128 v144, v[48:51] offset:1024
    ds_write_b128 v144, v[48:51] offset:2048
    s_add_u32 s13, s14, 2384
    v_lshl_add_u32 v145, v0, 2, s13
    s_add_u32 s13, s14, 2768
    v_lshl_add_u32 v146, v0, 1, s13
    s_add_u32 s14, s14, 64
    v_lshl_add_u32 v144, v0, 5, s14
    s_mul_i32 s15, s8, 3072
    s_sub_u32 s14, s14, s15
    s_lshl_b32 s15, s8, 7
    s_add_u32 s14, s14, s15
    s_add_u32 s14, s14, 36
    v_lshlrev_b32 v148, 3, v40
    v_sub_u32 v148, v41, v148
    v_lshl_add_u32 v148, v148, 2, s14
    v_add_u32 v149, 1024, v148
    s_sub_u32 s15, 2048, s15
    v_add_u32 v150, s15, v148
    v_add_u32 v151, 3072, v148
    v_add_u32 v152, 4096, v148
    s_mul_i32 s13, s9, 4608
    s_add_u32 s13, s13, 98912
    v_lshl_add_u32 v155, v41, 5, s13
    v_lshl_add_u32 v155, v40, 4, v155
    s_lshl_b32 s14, s8, 6
    v_subrev_u32 v153, s14, v155
    v_add_u32 v154, s9, v41
    v_and_b32 v154, 3, v154
    v_lshl_add_u32 v154, v154, 2, v40
    v_lshrrev_b32 v42, 2, v41
    v_mul_u32_u24 v42, 3088, v42
    v_lshl_add_u32 v154, v154, 4, v42
    v_add_u32 v154, s76, v154
    v_lshlrev_b32 v156, 4, v0
    v_add_u32 v156, 131136, v156
    v_add_u32 v157, -4, v144
    s_xor_b32 s14, s3, 4
    s_lshl_b32 s58, 1, s14
    s_mov_b32 s59, -1
    s_or_b32 s58, s58, 0x400
    v_mov_b32 v167, 6
    s_branch PRE2
PRE1:
    s_cmp_lg_u32 s7, 3
    s_cbranch_scc1 PRE2
    v_lshlrev_b32 v42, 3, v40
    v_sub_u32 v42, v42, v41
    v_add_u32 v42, 16, v42
    v_min_u32 v42, 31, v42
    s_mov_b32 s13, 0x10001
    s_movk_i32 s14, 0x3f80
    s_mov_b32 s12, 0x38000000
    v_lshrrev_b32 v43, v42, s12
    v_and_b32 v28, 0xaa, v43
    v_and_b32 v43, 0x55, v43
    v_lshl_or_b32 v43, v28, 15, v43
    v_and_b32 v144, s13, v43
    v_mul_u32_u24 v144, s14, v144
    v_lshrrev_b32 v43, 2, v43
    v_and_b32 v145, s13, v43
    v_mul_u32_u24 v145, s14, v145
    v_lshrrev_b32 v43, 2, v43
    v_and_b32 v146, s13, v43
    v_mul_u32_u24 v146, s14, v146
    v_lshrrev_b32 v43, 2, v43
    v_and_b32 v147, s13, v43
    v_mul_u32_u24 v147, s14, v147
    s_mov_b32 s12, 0x7c00000
    v_lshrrev_b32 v43, v42, s12
    v_and_b32 v28, 0xaa, v43
    v_and_b32 v43, 0x55, v43
    v_lshl_or_b32 v43, v28, 15, v43
    v_and_b32 v148, s13, v43
    v_mul_u32_u24 v148, s14, v148
    v_lshrrev_b32 v43, 2, v43
    v_and_b32 v149, s13, v43
    v_mul_u32_u24 v149, s14, v149
    v_lshrrev_b32 v43, 2, v43
    v_and_b32 v150, s13, v43
    v_mul_u32_u24 v150, s14, v150
    v_lshrrev_b32 v43, 2, v43
    v_and_b32 v151, s13, v43
    v_mul_u32_u24 v151, s14, v151
    s_mov_b32 s12, 0xfe00000
    v_lshrrev_b32 v43, v42, s12
    v_and_b32 v28, 0xaa, v43
    v_and_b32 v43, 0x55, v43
    v_lshl_or_b32 v43, v28, 15, v43
    v_and_b32 v152, s13, v43
    v_mul_u32_u24 v152, s14, v152
    v_lshrrev_b32 v43, 2, v43
    v_and_b32 v153, s13, v43
    v_mul_u32_u24 v153, s14, v153
    v_lshrrev_b32 v43, 2, v43
    v_and_b32 v154, s13, v43
    v_mul_u32_u24 v154, s14, v154
    v_lshrrev_b32 v43, 2, v43
    v_and_b32 v155, s13, v43
    v_mul_u32_u24 v155, s14, v155
    s_mov_b32 s12, 0x1ff00000
    v_lshrrev_b32 v43, v42, s12
    v_and_b32 v28, 0xaa, v43
    v_and_b32 v43, 0x55, v43
    v_lshl_or_b32 v43, v28, 15, v43
    v_and_b32 v156, s13, v43
    v_mul_u32_u24 v156, s14, v156
    v_lshrrev_b32 v43, 2, v43
    v_and_b32 v157, s13, v43
    v_mul_u32_u24 v157, s14, v157
    v_lshrrev_b32 v43, 2, v43
    v_and_b32 v158, s13, v43
    v_mul_u32_u24 v158, s14, v158
    v_lshrrev_b32 v43, 2, v43
    v_and_b32 v159, s13, v43
    v_mul_u32_u24 v159, s14, v159
PRE2:
    s_mov_b32 s78, 0
    s_mov_b32 s14, 0x3fb8aa3b
    s_mov_b32 s15, 0x3a800000
    s_cmp_eq_u32 s10, 1
    s_cselect_b32 s14, 0xbfb8aa3b, s14
    s_cselect_b32 s15, 0x3b000000, s15
    s_mov_b32 s60, 0x46800000
    s_mov_b32 s61, 0x3e800000
    s_mov_b32 s62, 0xffff6b6b
    s_cmp_eq_u32 s8, 1
    s_cselect_b32 s62, 0xfff6b6b, s62
    s_cmp_eq_u32 s8, 2
    s_cselect_b32 s62, 0xf000a0a, s62
    s_lshl_b32 s12, s7, 3
    s_lshr_b32 s62, s62, s12
    s_waitcnt vmcnt(5)
    s_cmp_eq_u32 s3, 3
    s_cbranch_scc1 KG_CONST0
    s_waitcnt vmcnt(0)
KG_CONST0:
KG_CONST:
    v_mul_f32 v14, 0x3fb8aa3b, v14
    v_exp_f32 v14, v14
    s_nop 0
    v_cvt_pk_bf16_f32 v14, v14, v14
    v_and_b32 v14, 0xffff0000, v14
    v_mul_f32 v16, s14, v14
    v_mul_f32 v17, 0x3e22f983, v14
    v_mul_f32 v20, s15, v14
    v_mul_f32 v18, 0x41000000, v16
    v_mul_f32 v19, 0x41000000, v17
KG_LOOP:
    s_bitcmp1_b32 s62, 1
    s_cbranch_scc1 NP1A
    s_setprio 0
    s_bitcmp0_b32 s62, 0
    s_cbranch_scc1 NP1B
    s_setprio 1
    s_branch NP1B
NP1A:
    s_setprio 2
    s_bitcmp0_b32 s62, 0
    s_cbranch_scc1 NP1B
    s_setprio 3
NP1B:
    s_lshr_b32 s62, s62, 2
    v_mul_f32 v30, 0x44800000, v4
    v_mul_f32 v31, 0x44800000, v5
    s_cmp_eq_u32 s10, 1
    s_cbranch_scc1 KG_B
    v_mul_f32 v28, v31, v7
    v_mul_f32 v31, v31, v6
    v_fmac_f32 v31, v30, v7
    v_fma_f32 v30, v30, v6, -v28
    s_branch KG_C
KG_B:
    v_mul_f32 v2, 0x3fb8aa3b, v2
    v_exp_f32 v2, v2
    s_nop 0
    v_cvt_pk_bf16_f32 v2, v2, v2
    v_and_b32 v2, 0xffff0000, v2
KG_C:
    v_mul_f32 v25, v3, v19
    v_mul_f32 v24, v2, v18
    v_mul_f32 v23, v3, v17
    v_mul_f32 v22, v2, v16
    v_fract_f32 v25, v25
    v_exp_f32 v26, v24
    v_fract_f32 v23, v23
    v_cos_f32 v24, v25
    v_sin_f32 v25, v25
    v_cmp_nge_f32 s[12:13], 0, v22
    v_exp_f32 v28, v22
    v_mul_f32 v24, v24, v26
    v_mul_f32 v25, v25, v26
    v_cos_f32 v22, v23
    v_sin_f32 v23, v23
    v_max_f32 v29, |v30|, |v31|
    v_mul_f32 v22, v22, v28
    v_mul_f32 v23, v23, v28
    v_cmp_nge_f32 vcc, s60, v29
    s_mov_b32 m0, s76
    s_or_b64 vcc, vcc, s[12:13]
    s_cbranch_scc1 KG_SLOW
    v_cmp_le_f32 vcc, s61, v29
    v_cvt_pk_f16_f32 v97, v24, v25
    s_cbranch_vccz KG_SLOW
    ds_write_addtid_b32 v97 offset:3088
    v_pk_mul_f32 v[26:27], v[24:25], v[24:25] op_sel_hi:[1,0]
    v_pk_fma_f32 v[24:25], v[24:25], v[24:25], v[26:27] op_sel:[1,1,0] op_sel_hi:[0,1,1] neg_lo:[1,0,0]
    v_cvt_pk_f16_f32 v98, v24, v25
    ds_write_addtid_b32 v98 offset:6176
    v_pk_mul_f16 v28, v97, v98 op_sel_hi:[1,0]
    v_pk_fma_f16 v99, v97, v98, v28 op_sel:[1,1,0] op_sel_hi:[0,1,1] neg_lo:[1,0,0]
    ds_write_addtid_b32 v99 offset:9264
    v_pk_mul_f32 v[26:27], v[24:25], v[24:25] op_sel_hi:[1,0]
    v_pk_fma_f32 v[24:25], v[24:25], v[24:25], v[26:27] op_sel:[1,1,0] op_sel_hi:[0,1,1] neg_lo:[1,0,0]
    v_cvt_pk_f16_f32 v100, v24, v25
    ds_write_addtid_b32 v100 offset:12352
    v_pk_mul_f16 v28, v97, v100 op_sel_hi:[1,0]
    v_pk_fma_f16 v101, v97, v100, v28 op_sel:[1,1,0] op_sel_hi:[0,1,1] neg_lo:[1,0,0]
    ds_write_addtid_b32 v101 offset:15440
    v_pk_mul_f16 v28, v98, v100 op_sel_hi:[1,0]
    v_pk_fma_f16 v102, v98, v100, v28 op_sel:[1,1,0] op_sel_hi:[0,1,1] neg_lo:[1,0,0]
    ds_write_addtid_b32 v102 offset:18528
    v_pk_mul_f16 v28, v99, v100 op_sel_hi:[1,0]
    v_pk_fma_f16 v103, v99, v100, v28 op_sel:[1,1,0] op_sel_hi:[0,1,1] neg_lo:[1,0,0]
    ds_write_addtid_b32 v103 offset:21616
    v_pk_mul_f32 v[26:27], v[24:25], v[24:25] op_sel_hi:[1,0]
    v_pk_fma_f32 v[24:25], v[24:25], v[24:25], v[26:27] op_sel:[1,1,0] op_sel_hi:[0,1,1] neg_lo:[1,0,0]
    v_cvt_pk_f16_f32 v104, v24, v25
    ds_write_addtid_b32 v104 offset:24704
    v_pk_mul_f16 v28, v97, v104 op_sel_hi:[1,0]
    v_pk_fma_f16 v105, v97, v104, v28 op_sel:[1,1,0] op_sel_hi:[0,1,1] neg_lo:[1,0,0]
    ds_write_addtid_b32 v105 offset:27792
    v_pk_mul_f16 v28, v98, v104 op_sel_hi:[1,0]
    v_pk_fma_f16 v106, v98, v104, v28 op_sel:[1,1,0] op_sel_hi:[0,1,1] neg_lo:[1,0,0]
    ds_write_addtid_b32 v106 offset:30880
    v_pk_mul_f16 v28, v99, v104 op_sel_hi:[1,0]
    v_pk_fma_f16 v107, v99, v104, v28 op_sel:[1,1,0] op_sel_hi:[0,1,1] neg_lo:[1,0,0]
    ds_write_addtid_b32 v107 offset:33968
    v_pk_mul_f16 v28, v100, v104 op_sel_hi:[1,0]
    v_pk_fma_f16 v108, v100, v104, v28 op_sel:[1,1,0] op_sel_hi:[0,1,1] neg_lo:[1,0,0]
    ds_write_addtid_b32 v108 offset:37056
    v_pk_mul_f16 v28, v101, v104 op_sel_hi:[1,0]
    v_pk_fma_f16 v109, v101, v104, v28 op_sel:[1,1,0] op_sel_hi:[0,1,1] neg_lo:[1,0,0]
    ds_write_addtid_b32 v109 offset:40144
    v_pk_mul_f16 v28, v102, v104 op_sel_hi:[1,0]
    v_pk_fma_f16 v110, v102, v104, v28 op_sel:[1,1,0] op_sel_hi:[0,1,1] neg_lo:[1,0,0]
    ds_write_addtid_b32 v110 offset:43232
    v_pk_mul_f16 v28, v103, v104 op_sel_hi:[1,0]
    v_pk_fma_f16 v111, v103, v104, v28 op_sel:[1,1,0] op_sel_hi:[0,1,1] neg_lo:[1,0,0]
    ds_write_addtid_b32 v111 offset:46320
    v_pk_mul_f32 v[26:27], v[24:25], v[24:25] op_sel_hi:[1,0]
    v_pk_fma_f32 v[24:25], v[24:25], v[24:25], v[26:27] op_sel:[1,1,0] op_sel_hi:[0,1,1] neg_lo:[1,0,0]
    s_mov_b32 m0, s77
    v_cvt_pk_f16_f32 v112, v24, v25
    ds_write_addtid_b32 v112 offset:15440
    v_pk_mul_f16 v28, v97, v112 op_sel_hi:[1,0]
    v_pk_fma_f16 v40, v97, v112, v28 op_sel:[1,1,0] op_sel_hi:[0,1,1] neg_lo:[1,0,0]
    ds_write_addtid_b32 v40 offset:18528
    v_pk_mul_f16 v28, v98, v112 op_sel_hi:[1,0]
    v_pk_fma_f16 v41, v98, v112, v28 op_sel:[1,1,0] op_sel_hi:[0,1,1] neg_lo:[1,0,0]
    ds_write_addtid_b32 v41 offset:21616
    v_pk_mul_f16 v28, v99, v112 op_sel_hi:[1,0]
    v_pk_fma_f16 v42, v99, v112, v28 op_sel:[1,1,0] op_sel_hi:[0,1,1] neg_lo:[1,0,0]
    ds_write_addtid_b32 v42 offset:24704
    v_pk_mul_f16 v28, v100, v112 op_sel_hi:[1,0]
    v_pk_fma_f16 v43, v100, v112, v28 op_sel:[1,1,0] op_sel_hi:[0,1,1] neg_lo:[1,0,0]
    ds_write_addtid_b32 v43 offset:27792
    v_pk_mul_f16 v28, v101, v112 op_sel_hi:[1,0]
    v_pk_fma_f16 v40, v101, v112, v28 op_sel:[1,1,0] op_sel_hi:[0,1,1] neg_lo:[1,0,0]
    ds_write_addtid_b32 v40 offset:30880
    v_pk_mul_f16 v28, v102, v112 op_sel_hi:[1,0]
    v_pk_fma_f16 v41, v102, v112, v28 op_sel:[1,1,0] op_sel_hi:[0,1,1] neg_lo:[1,0,0]
    ds_write_addtid_b32 v41 offset:33968
    v_pk_mul_f16 v28, v103, v112 op_sel_hi:[1,0]
    v_pk_fma_f16 v42, v103, v112, v28 op_sel:[1,1,0] op_sel_hi:[0,1,1] neg_lo:[1,0,0]
    ds_write_addtid_b32 v42 offset:37056
    v_pk_mul_f16 v28, v104, v112 op_sel_hi:[1,0]
    v_pk_fma_f16 v43, v104, v112, v28 op_sel:[1,1,0] op_sel_hi:[0,1,1] neg_lo:[1,0,0]
    ds_write_addtid_b32 v43 offset:40144
    v_pk_mul_f16 v28, v105, v112 op_sel_hi:[1,0]
    v_pk_fma_f16 v40, v105, v112, v28 op_sel:[1,1,0] op_sel_hi:[0,1,1] neg_lo:[1,0,0]
    ds_write_addtid_b32 v40 offset:43232
    v_pk_mul_f16 v28, v106, v112 op_sel_hi:[1,0]
    v_pk_fma_f16 v41, v106, v112, v28 op_sel:[1,1,0] op_sel_hi:[0,1,1] neg_lo:[1,0,0]
    ds_write_addtid_b32 v41 offset:46320
    v_pk_mul_f16 v28, v107, v112 op_sel_hi:[1,0]
    v_pk_fma_f16 v42, v107, v112, v28 op_sel:[1,1,0] op_sel_hi:[0,1,1] neg_lo:[1,0,0]
    ds_write_addtid_b32 v42 offset:49408
    v_pk_mul_f16 v28, v108, v112 op_sel_hi:[1,0]
    v_pk_fma_f16 v43, v108, v112, v28 op_sel:[1,1,0] op_sel_hi:[0,1,1] neg_lo:[1,0,0]
    ds_write_addtid_b32 v43 offset:52496
    v_pk_mul_f16 v28, v109, v112 op_sel_hi:[1,0]
    v_pk_fma_f16 v40, v109, v112, v28 op_sel:[1,1,0] op_sel_hi:[0,1,1] neg_lo:[1,0,0]
    ds_write_addtid_b32 v40 offset:55584
    v_pk_mul_f16 v28, v110, v112 op_sel_hi:[1,0]
    v_pk_fma_f16 v41, v110, v112, v28 op_sel:[1,1,0] op_sel_hi:[0,1,1] neg_lo:[1,0,0]
    ds_write_addtid_b32 v41 offset:58672
    v_pk_mul_f16 v28, v111, v112 op_sel_hi:[1,0]
    v_pk_fma_f16 v42, v111, v112, v28 op_sel:[1,1,0] op_sel_hi:[0,1,1] neg_lo:[1,0,0]
    ds_write_addtid_b32 v42 offset:61760
    v_pk_mul_f32 v[26:27], v[24:25], v[24:25] op_sel_hi:[1,0]
    v_pk_fma_f32 v[24:25], v[24:25], v[24:25], v[26:27] op_sel:[1,1,0] op_sel_hi:[0,1,1] neg_lo:[1,0,0]
    ds_read_b128 v[64:67], v44 offset:0
    ds_read_b128 v[68:71], v44 offset:32
    ds_read_b128 v[72:75], v44 offset:64
    ds_read_b128 v[76:79], v44 offset:96
    ds_read_b128 v[80:83], v44 offset:128
    ds_read_b128 v[84:87], v44 offset:160
    ds_read_b128 v[88:91], v44 offset:192
    ds_read_b128 v[92:95], v44 offset:224
    s_bitcmp1_b32 s62, 1
    s_cbranch_scc1 NP2A
    s_setprio 0
    s_bitcmp0_b32 s62, 0
    s_cbranch_scc1 NP2B
    s_setprio 1
    s_branch NP2B
NP2A:
    s_setprio 2
    s_bitcmp0_b32 s62, 0
    s_cbranch_scc1 NP2B
    s_setprio 3
NP2B:
    s_lshr_b32 s62, s62, 2
    s_mov_b32 m0, s76
    v_cvt_pk_f16_f32 v32, v30, -v31
    v_cvt_pk_f16_f32 v22, v22, v23
    v_cvt_pk_f16_f32 v24, v24, v25
    ds_write_addtid_b32 v32 offset:3088
    v_pk_mul_f16 v28, v32, v22 op_sel_hi:[1,0]
    v_pk_fma_f16 v40, v32, v22, v28 op_sel:[1,1,0] op_sel_hi:[0,1,1] neg_hi:[1,0,0]
    ds_write_addtid_b32 v40 offset:24704
    v_pk_mul_f16 v28, v40, v22 op_sel_hi:[1,0]
    v_pk_fma_f16 v33, v40, v22, v28 op_sel:[1,1,0] op_sel_hi:[0,1,1] neg_hi:[1,0,0]
    ds_write_addtid_b32 v33 offset:27792
    v_pk_mul_f16 v28, v33, v22 op_sel_hi:[1,0]
    v_pk_fma_f16 v41, v33, v22, v28 op_sel:[1,1,0] op_sel_hi:[0,1,1] neg_hi:[1,0,0]
    ds_write_addtid_b32 v41 offset:30880
    v_pk_mul_f16 v28, v41, v22 op_sel_hi:[1,0]
    v_pk_fma_f16 v34, v41, v22, v28 op_sel:[1,1,0] op_sel_hi:[0,1,1] neg_hi:[1,0,0]
    ds_write_addtid_b32 v34 offset:33968
    v_pk_mul_f16 v28, v34, v22 op_sel_hi:[1,0]
    v_pk_fma_f16 v42, v34, v22, v28 op_sel:[1,1,0] op_sel_hi:[0,1,1] neg_hi:[1,0,0]
    ds_write_addtid_b32 v42 offset:49408
    v_pk_mul_f16 v28, v42, v22 op_sel_hi:[1,0]
    v_pk_fma_f16 v35, v42, v22, v28 op_sel:[1,1,0] op_sel_hi:[0,1,1] neg_hi:[1,0,0]
    ds_write_addtid_b32 v35 offset:52496
    v_pk_mul_f16 v28, v35, v22 op_sel_hi:[1,0]
    v_pk_fma_f16 v43, v35, v22, v28 op_sel:[1,1,0] op_sel_hi:[0,1,1] neg_hi:[1,0,0]
    ds_write_addtid_b32 v43 offset:55584
    v_pk_mul_f16 v28, v32, v97 op_sel_hi:[1,0]
    v_pk_fma_f16 v36, v32, v97, v28 op_sel:[1,1,0] op_sel_hi:[0,1,1] neg_hi:[1,0,0]
    ds_write_addtid_b32 v36 offset:58672
    s_mov_b32 m0, s77
    v_pk_mul_f16 v28, v33, v24 op_sel_hi:[1,0]
    v_pk_fma_f16 v33, v33, v24, v28 op_sel:[1,1,0] op_sel_hi:[0,1,1] neg_hi:[1,0,0]
    ds_write_addtid_b32 v33 offset:6176
    v_pk_mul_f16 v28, v34, v24 op_sel_hi:[1,0]
    v_pk_fma_f16 v34, v34, v24, v28 op_sel:[1,1,0] op_sel_hi:[0,1,1] neg_hi:[1,0,0]
    ds_write_addtid_b32 v34 offset:9264
    v_pk_mul_f16 v28, v35, v24 op_sel_hi:[1,0]
    v_pk_fma_f16 v35, v35, v24, v28 op_sel:[1,1,0] op_sel_hi:[0,1,1] neg_hi:[1,0,0]
    ds_write_addtid_b32 v35 offset:30880
    v_pk_mul_f16 v28, v36, v24 op_sel_hi:[1,0]
    v_pk_fma_f16 v36, v36, v24, v28 op_sel:[1,1,0] op_sel_hi:[0,1,1] neg_hi:[1,0,0]
    ds_write_addtid_b32 v36 offset:37056
    v_pk_mul_f16 v28, v34, v24 op_sel_hi:[1,0]
    v_pk_fma_f16 v34, v34, v24, v28 op_sel:[1,1,0] op_sel_hi:[0,1,1] neg_hi:[1,0,0]
    ds_write_addtid_b32 v34 offset:40144
    v_pk_mul_f16 v28, v36, v24 op_sel_hi:[1,0]
    v_pk_fma_f16 v36, v36, v24, v28 op_sel:[1,1,0] op_sel_hi:[0,1,1] neg_hi:[1,0,0]
    ds_write_addtid_b32 v36 offset:43232
    v_pk_mul_f16 v28, v34, v24 op_sel_hi:[1,0]
    v_pk_fma_f16 v34, v34, v24, v28 op_sel:[1,1,0] op_sel_hi:[0,1,1] neg_hi:[1,0,0]
    ds_write_addtid_b32 v34 offset:52496
    v_pk_mul_f16 v28, v36, v24 op_sel_hi:[1,0]
    v_pk_fma_f16 v36, v36, v24, v28 op_sel:[1,1,0] op_sel_hi:[0,1,1] neg_hi:[1,0,0]
    ds_write_addtid_b32 v36 offset:55584
    v_pk_mul_f16 v28, v36, v24 op_sel_hi:[1,0]
    v_pk_fma_f16 v36, v36, v24, v28 op_sel:[1,1,0] op_sel_hi:[0,1,1] neg_hi:[1,0,0]
    ds_write_addtid_b32 v36 offset:46320
    v_pk_mul_f16 v28, v36, v24 op_sel_hi:[1,0]
    v_pk_fma_f16 v36, v36, v24, v28 op_sel:[1,1,0] op_sel_hi:[0,1,1] neg_hi:[1,0,0]
    ds_write_addtid_b32 v36 offset:58672
    v_pk_mul_f16 v28, v36, v24 op_sel_hi:[1,0]
    v_pk_fma_f16 v36, v36, v24, v28 op_sel:[1,1,0] op_sel_hi:[0,1,1] neg_hi:[1,0,0]
    ds_write_addtid_b32 v36 offset:49408
    v_pk_mul_f16 v28, v36, v24 op_sel_hi:[1,0]
    v_pk_fma_f16 v36, v36, v24, v28 op_sel:[1,1,0] op_sel_hi:[0,1,1] neg_hi:[1,0,0]
    ds_write_addtid_b32 v36 offset:61760
    s_cmp_lg_u32 s78, 1
    s_cbranch_scc1 KG_NPF
    ds_read_b32 v28, v46
    ds_read_b128 v[128:131], v147 offset:0
    ds_read_b128 v[132:135], v147 offset:12352
    ds_read_b128 v[136:139], v147 offset:24704
    ds_read_b128 v[140:143], v147 offset:37056
KG_NPF:
    ds_read_b128 v[96:99], v44 offset:0
    ds_read_b128 v[100:103], v44 offset:32
    ds_read_b128 v[104:107], v44 offset:64
    ds_read_b128 v[108:111], v44 offset:96
    ds_read_b128 v[112:115], v44 offset:128
    ds_read_b128 v[116:119], v44 offset:160
    ds_read_b128 v[120:123], v44 offset:192
    ds_read_b128 v[124:127], v44 offset:224
    s_waitcnt vmcnt(0)
    v_mov_b32 v2, v8
    v_mov_b32 v3, v9
    v_mov_b32 v4, v10
    v_mov_b32 v5, v11
    v_mov_b32 v6, v12
    v_mov_b32 v7, v13
    s_and_b32 s12, s78, s8
    s_cmp_lg_u32 s12, 1
    s_cbranch_scc1 KG_MF
    s_mov_b32 s59, 0
    s_waitcnt lgkmcnt(4)
    v_mfma_f32_32x32x16_f16 v[48:63], v[96:99], v[64:67], v[48:63]
    s_waitcnt lgkmcnt(0)
    v_mfma_f32_32x32x16_f16 v[48:63], v[100:103], v[68:71], v[48:63]
    v_mfma_f32_32x32x16_f16 v[48:63], v[104:107], v[72:75], v[48:63]
    v_mfma_f32_32x32x16_f16 v[48:63], v[108:111], v[76:79], v[48:63]
    v_mfma_f32_32x32x16_f16 v[48:63], v[112:115], v[80:83], v[48:63]
    ds_read_b32 v29, v46
    ds_read2_b32 v[64:65], v148 offset0:6 offset1:4
    ds_read2_b32 v[66:67], v148 offset0:2 offset1:0
    ds_read2_b32 v[68:69], v148 offset0:70 offset1:68
    ds_read2_b32 v[70:71], v148 offset0:66 offset1:64
    v_mfma_f32_32x32x16_f16 v[48:63], v[116:119], v[84:87], v[48:63]
    ds_read2_b32 v[72:73], v148 offset0:134 offset1:132
    ds_read2_b32 v[74:75], v148 offset0:130 offset1:128
    ds_read2_b32 v[76:77], v148 offset0:198 offset1:196
    ds_read2_b32 v[78:79], v148 offset0:194 offset1:192
    v_mfma_f32_32x32x16_f16 v[48:63], v[120:123], v[88:91], v[48:63]
    ds_read2_b32 v[80:81], v149 offset0:6 offset1:4
    ds_read2_b32 v[82:83], v149 offset0:2 offset1:0
    ds_read2_b32 v[84:85], v149 offset0:70 offset1:68
    ds_read2_b32 v[86:87], v149 offset0:66 offset1:64
    v_mfma_f32_32x32x16_f16 v[48:63], v[124:127], v[92:95], v[48:63]
    ds_read2_b32 v[88:89], v149 offset0:134 offset1:132
    ds_read2_b32 v[90:91], v149 offset0:130 offset1:128
    ds_read2_b32 v[92:93], v149 offset0:198 offset1:196
    ds_read2_b32 v[94:95], v149 offset0:194 offset1:192
    s_branch KG_JOIN
KG_MF:
    s_waitcnt lgkmcnt(6)
    v_mfma_f32_32x32x16_f16 v[48:63], v[96:99], v[64:67], v[48:63]
    s_waitcnt lgkmcnt(4)
    v_mfma_f32_32x32x16_f16 v[48:63], v[100:103], v[68:71], v[48:63]
    s_waitcnt lgkmcnt(2)
    v_mfma_f32_32x32x16_f16 v[48:63], v[104:107], v[72:75], v[48:63]
    s_waitcnt lgkmcnt(0)
    v_mfma_f32_32x32x16_f16 v[48:63], v[108:111], v[76:79], v[48:63]
    v_mfma_f32_32x32x16_f16 v[48:63], v[112:115], v[80:83], v[48:63]
    v_mfma_f32_32x32x16_f16 v[48:63], v[116:119], v[84:87], v[48:63]
    v_mfma_f32_32x32x16_f16 v[48:63], v[120:123], v[88:91], v[48:63]
    v_mfma_f32_32x32x16_f16 v[48:63], v[124:127], v[92:95], v[48:63]
KG_JOIN:
    s_cmp_eq_u32 s11, 1
    s_cbranch_scc1 ONEW
    s_add_u32 s78, s78, 1
    s_cmp_eq_u32 s78, 1
    s_cbranch_scc1 KG_LOOP
    s_setprio 3
    v_cmp_le_u32 vcc, s57, v28
    s_andn2_b32 s12, s56, vcc_lo
    s_cbranch_scc0 KG_HAVE
    s_mov_b32 s1, 0
POLL_3:
    ds_read_b32 v28, v46
    s_waitcnt lgkmcnt(0)
    v_cmp_le_u32 vcc, s57, v28
    s_andn2_b32 s12, s56, vcc_lo
    s_cbranch_scc0 POLL_3_X
    s_sleep 1
    s_add_u32 s1, s1, 1
    s_cmp_lt_u32 s1, 0x8000
    s_cbranch_scc1 POLL_3
POLL_3_X:
    ds_read_b128 v[128:131], v147 offset:0
    ds_read_b128 v[132:135], v147 offset:12352
    ds_read_b128 v[136:139], v147 offset:24704
    ds_read_b128 v[140:143], v147 offset:37056
    s_waitcnt lgkmcnt(0)
KG_HAVE:
    s_cmp_eq_u32 s8, 0
    s_cbranch_scc1 NOEARLY
    ds_read_b128 v[2:5], v153 offset:384
    ds_read_b128 v[6:9], v153 offset:256
    ds_read_b128 v[10:13], v153 offset:128
    ds_read_b128 v[14:17], v153 offset:0
    ds_read_b128 v[162:165], v156 offset:0
NOEARLY:
    v_add_f32 v129, v129, v166
    v_fma_f32 v59, v59, v20, v139
    v_fma_f32 v51, v49, v20, v129
    v_fma_f32 v52, v52, v20, v132
    v_fma_f32 v53, v53, v20, v133
    v_fma_f32 v54, v54, v20, v134
    v_fma_f32 v55, v55, v20, v135
    v_fma_f32 v56, v56, v20, v136
    v_fma_f32 v57, v57, v20, v137
    v_fma_f32 v58, v58, v20, v138
    v_mov_b32_dpp v51, v59 wave_shr:1 row_mask:0xf bank_mask:0xf
    s_mov_b32 exec_lo, 0
    v_mov_b32 v55, v54
    v_mov_b32 v56, v54
    v_mov_b32 v58, v59
    v_mov_b32 v52, v51
    s_mov_b32 exec_lo, -1
    v_cvt_pk_bf16_f32 v132, v52, v51
    v_cvt_pk_bf16_f32 v133, v53, v52
    v_cvt_pk_bf16_f32 v134, v54, v53
    v_cvt_pk_bf16_f32 v135, v55, v54
    ds_write_b128 v144, v[132:135]
    v_cvt_pk_bf16_f32 v136, v56, v55
    v_cvt_pk_bf16_f32 v137, v57, v56
    v_cvt_pk_bf16_f32 v138, v58, v57
    v_cvt_pk_bf16_f32 v139, v59, v58
    ds_write_b128 v144, v[136:139] offset:16
    v_cvt_pk_bf16_f32 v128, v51, 0
    s_mov_b64 exec, 1
    ds_write_b32 v157, v128
    s_mov_b64 exec, -1
    s_cmp_eq_u32 s8, 0
    s_cbranch_scc1 FIRST_X
    ds_write_b32 v47, v167
    ds_read2_b32 v[96:97], v151 offset0:6 offset1:4
    ds_read2_b32 v[98:99], v151 offset0:2 offset1:0
    ds_read2_b32 v[100:101], v151 offset0:70 offset1:68
    ds_read2_b32 v[102:103], v151 offset0:66 offset1:64
    ds_read2_b32 v[104:105], v151 offset0:134 offset1:132
    ds_read2_b32 v[106:107], v151 offset0:130 offset1:128
    ds_read2_b32 v[108:109], v151 offset0:198 offset1:196
    ds_read2_b32 v[110:111], v151 offset0:194 offset1:192
    v_fma_f32 v140, v60, v20, v140
    v_fma_f32 v141, v61, v20, v141
    v_fma_f32 v142, v62, v20, v142
    v_fma_f32 v143, v63, v20, v143
    v_cvt_pk_bf16_f32 v140, v140, v141
    v_cvt_pk_bf16_f32 v141, v142, v143
    ds_write_b32 v145, v140
    ds_write_b16 v146, v141
    ds_write_b16_d16_hi v146, v141 offset:128
    v_mov_b32 v167, 7
    ds_write_b32 v47, v167
    s_waitcnt lgkmcnt(12)
    v_cmp_le_u32 vcc, 6, v29
    s_andn2_b32 s12, s58, vcc_lo
    s_andn2_b32 s79, 0x2000, vcc_lo
    s_or_b32 s12, s12, s59
    s_cbranch_scc1 FIRST_Y
FIRST_GO:
    v_mfma_f32_16x16x32_bf16 v[48:51], v[64:67], v[2:5], 0
    v_add_u32 v167, 1, v167
    v_mfma_f32_16x16x32_bf16 v[48:51], v[68:71], v[6:9], v[48:51]
    v_add_u32 v23, 3072, v150
    v_mfma_f32_16x16x32_bf16 v[48:51], v[72:75], v[10:13], v[48:51]
    v_mfma_f32_16x16x32_bf16 v[48:51], v[76:79], v[14:17], v[48:51]
    s_waitcnt lgkmcnt(6)
    v_mfma_f32_16x16x32_bf16 v[52:55], v[96:99], v[2:5], 0
    s_waitcnt lgkmcnt(4)
    v_mfma_f32_16x16x32_bf16 v[52:55], v[100:103], v[6:9], v[52:55]
    s_waitcnt lgkmcnt(2)
    v_mfma_f32_16x16x32_bf16 v[52:55], v[104:107], v[10:13], v[52:55]
    s_waitcnt lgkmcnt(0)
    v_mfma_f32_16x16x32_bf16 v[52:55], v[108:111], v[14:17], v[52:55]
    s_cmp_lg_u32 s79, 0
    s_cbranch_scc1 G_SLOW
G_GO:
    v_mfma_f32_16x16x32_bf16 v[56:59], v[80:83], v[2:5], 0
    ds_read2_b32 v[112:113], v152 offset0:6 offset1:4
    ds_read2_b32 v[114:115], v152 offset0:2 offset1:0
    v_mfma_f32_16x16x32_bf16 v[56:59], v[84:87], v[6:9], v[56:59]
    ds_read2_b32 v[116:117], v152 offset0:70 offset1:68
    ds_read2_b32 v[118:119], v152 offset0:66 offset1:64
    v_sub_f32 v158, v48, v52
    v_fma_f32 v158, v158, v162, v52
    v_sub_f32 v159, v49, v53
    v_fma_f32 v159, v159, v163, v53
    v_sub_f32 v160, v50, v54
    v_fma_f32 v160, v160, v164, v54
    v_sub_f32 v161, v51, v55
    v_fma_f32 v161, v161, v165, v55
    ds_write_b128 v154, v[158:161] offset:0
    ds_write_b32 v47, v167
    s_cmp_lg_u32 s8, 0
    s_cbranch_scc1 XM0
    s_setprio 2
XM0:
    v_mfma_f32_16x16x32_bf16 v[56:59], v[88:91], v[10:13], v[56:59]
    ds_read2_b32 v[120:121], v152 offset0:134 offset1:132
    ds_read2_b32 v[122:123], v152 offset0:130 offset1:128
    v_mfma_f32_16x16x32_bf16 v[56:59], v[92:95], v[14:17], v[56:59]
    ds_read2_b32 v[124:125], v152 offset0:198 offset1:196
    ds_read2_b32 v[126:127], v152 offset0:194 offset1:192
    s_cmp_eq_u32 s8, 0
    s_cbranch_scc1 NOLP
    v_mov_b32 v24, v139
    v_mov_b32 v25, v139
    v_and_b32 v26, 0xffff0000, v139
    v_mov_b32 v27, 0
    s_mov_b32 exec_lo, 0
    s_brev_b32 exec_hi, 1
    ds_write_b128 v144, v[24:27] offset:32
    s_mov_b64 exec, -1
    v_lshrrev_b32 v32, 16, v140
    v_and_b32 v34, 0xffff0000, v140
    v_or_b32 v33, v32, v34
    v_mov_b32 v35, 0
    s_mov_b32 exec_lo, 0
    s_brev_b32 exec_hi, 1
    ds_write_b128 v144, v[32:35] offset:160
    s_mov_b64 exec, -1
NOLP:
    s_waitcnt lgkmcnt(8)
    v_mfma_f32_16x16x32_bf16 v[60:63], v[112:115], v[2:5], 0
    ds_read_b128 v[24:27], v153 offset:896
    s_waitcnt lgkmcnt(7)
    v_mfma_f32_16x16x32_bf16 v[60:63], v[116:119], v[6:9], v[60:63]
    ds_read_b128 v[28:31], v153 offset:768
    s_waitcnt lgkmcnt(4)
    v_mfma_f32_16x16x32_bf16 v[60:63], v[120:123], v[10:13], v[60:63]
    ds_read_b128 v[32:35], v153 offset:640
    s_waitcnt lgkmcnt(3)
    v_mfma_f32_16x16x32_bf16 v[60:63], v[124:127], v[14:17], v[60:63]
    ds_read_b128 v[36:39], v153 offset:512
    s_waitcnt lgkmcnt(3)
    v_mfma_f32_16x16x32_bf16 v[56:59], v[64:67], v[24:27], v[56:59]
    ds_read_b128 v[162:165], v156 offset:1024
    v_add_u32 v167, 1, v167
    v_mfma_f32_16x16x32_bf16 v[60:63], v[96:99], v[24:27], v[60:63]
    ds_read_b128 v[2:5], v153 offset:1408
    s_waitcnt lgkmcnt(4)
    v_mfma_f32_16x16x32_bf16 v[56:59], v[68:71], v[28:31], v[56:59]
    ds_read_b128 v[6:9], v153 offset:1280
    v_mfma_f32_16x16x32_bf16 v[60:63], v[100:103], v[28:31], v[60:63]
    ds_read_b128 v[10:13], v153 offset:1152
    s_waitcnt lgkmcnt(5)
    v_mfma_f32_16x16x32_bf16 v[56:59], v[72:75], v[32:35], v[56:59]
    ds_read_b128 v[14:17], v153 offset:1024
    v_mfma_f32_16x16x32_bf16 v[60:63], v[104:107], v[32:35], v[60:63]
    s_cmp_lg_u32 s8, 1
    s_cbranch_scc1 XL1
    ds_read_b128 v[18:21], v155 offset:384
    ds_read2_b32 v[128:129], v150 offset0:6 offset1:4
    ds_read2_b32 v[130:131], v150 offset0:2 offset1:0
    ds_read2_b32 v[132:133], v23 offset0:6 offset1:4
    ds_read2_b32 v[134:135], v23 offset0:2 offset1:0
XL1:
    s_waitcnt lgkmcnt(5)
    v_mfma_f32_16x16x32_bf16 v[56:59], v[76:79], v[36:39], v[56:59]
    v_mfma_f32_16x16x32_bf16 v[60:63], v[108:111], v[36:39], v[60:63]
    v_mfma_f32_16x16x32_bf16 v[48:51], v[80:83], v[24:27], 0
    v_mfma_f32_16x16x32_bf16 v[52:55], v[112:115], v[24:27], 0
    s_nop 4
    v_mfma_f32_16x16x32_bf16 v[48:51], v[84:87], v[28:31], v[48:51]
    s_waitcnt lgkmcnt(4)
    v_sub_f32 v158, v56, v60
    v_fma_f32 v158, v158, v162, v60
    v_mfma_f32_16x16x32_bf16 v[52:55], v[116:119], v[28:31], v[52:55]
    v_sub_f32 v159, v57, v61
    v_fma_f32 v159, v159, v163, v61
    v_mfma_f32_16x16x32_bf16 v[48:51], v[88:91], v[32:35], v[48:51]
    v_sub_f32 v160, v58, v62
    v_fma_f32 v160, v160, v164, v62
    v_mfma_f32_16x16x32_bf16 v[52:55], v[120:123], v[32:35], v[52:55]
    v_sub_f32 v161, v59, v63
    v_fma_f32 v161, v161, v165, v63
    v_mfma_f32_16x16x32_bf16 v[48:51], v[92:95], v[36:39], v[48:51]
    ds_write_b128 v154, v[158:161] offset:12352
    v_mfma_f32_16x16x32_bf16 v[52:55], v[124:127], v[36:39], v[52:55]
    ds_write_b32 v47, v167
    s_cmp_lg_u32 s8, 1
    s_cbranch_scc1 XM1
    s_setprio 2
    s_waitcnt lgkmcnt(2)
    v_mfma_f32_16x16x32_bf16 v[48:51], v[128:131], v[18:21], v[48:51]
    v_mfma_f32_16x16x32_bf16 v[52:55], v[132:135], v[18:21], v[52:55]
XM1:
    s_waitcnt lgkmcnt(5)
    v_mfma_f32_16x16x32_bf16 v[48:51], v[64:67], v[2:5], v[48:51]
    v_mfma_f32_16x16x32_bf16 v[52:55], v[96:99], v[2:5], v[52:55]
    s_mov_b32 s1, 0
POLL_4:
    ds_read_b32 v166, v46
    s_waitcnt lgkmcnt(0)
    v_cmp_le_u32 vcc, 9, v166
    s_andn2_b32 s12, s58, vcc_lo
    s_cbranch_scc0 POLL_4_X
    s_sleep 1
    s_add_u32 s1, s1, 1
    s_cmp_lt_u32 s1, 0x8000
    s_cbranch_scc1 POLL_4
POLL_4_X:
    v_mfma_f32_16x16x32_bf16 v[48:51], v[68:71], v[6:9], v[48:51]
    ds_read_b128 v[162:165], v156 offset:2048
    v_add_u32 v167, 1, v167
    v_mfma_f32_16x16x32_bf16 v[52:55], v[100:103], v[6:9], v[52:55]
    ds_read_b128 v[24:27], v153 offset:1920
    v_mfma_f32_16x16x32_bf16 v[48:51], v[72:75], v[10:13], v[48:51]
    ds_read_b128 v[28:31], v153 offset:1792
    v_mfma_f32_16x16x32_bf16 v[52:55], v[104:107], v[10:13], v[52:55]
    ds_read_b128 v[32:35], v153 offset:1664
    v_mfma_f32_16x16x32_bf16 v[48:51], v[76:79], v[14:17], v[48:51]
    ds_read_b128 v[36:39], v153 offset:1536
    v_mfma_f32_16x16x32_bf16 v[52:55], v[108:111], v[14:17], v[52:55]
    s_cmp_lg_u32 s8, 0
    s_cbranch_scc1 XL2
    ds_read_b128 v[18:21], v155 offset:896
    ds_read2_b32 v[128:129], v150 offset0:6 offset1:4
    ds_read2_b32 v[130:131], v150 offset0:2 offset1:0
    ds_read2_b32 v[132:133], v23 offset0:6 offset1:4
    ds_read2_b32 v[134:135], v23 offset0:2 offset1:0
XL2:
    v_mfma_f32_16x16x32_bf16 v[56:59], v[80:83], v[2:5], 0
    v_mfma_f32_16x16x32_bf16 v[60:63], v[112:115], v[2:5], 0
    s_nop 4
    v_mfma_f32_16x16x32_bf16 v[56:59], v[84:87], v[6:9], v[56:59]
    s_waitcnt lgkmcnt(4)
    v_sub_f32 v158, v48, v52
    v_fma_f32 v158, v158, v162, v52
    v_mfma_f32_16x16x32_bf16 v[60:63], v[116:119], v[6:9], v[60:63]
    v_sub_f32 v159, v49, v53
    v_fma_f32 v159, v159, v163, v53
    v_mfma_f32_16x16x32_bf16 v[56:59], v[88:91], v[10:13], v[56:59]
    v_sub_f32 v160, v50, v54
    v_fma_f32 v160, v160, v164, v54
    v_mfma_f32_16x16x32_bf16 v[60:63], v[120:123], v[10:13], v[60:63]
    v_sub_f32 v161, v51, v55
    v_fma_f32 v161, v161, v165, v55
    v_mfma_f32_16x16x32_bf16 v[56:59], v[92:95], v[14:17], v[56:59]
    ds_write_b128 v154, v[158:161] offset:24704
    v_mfma_f32_16x16x32_bf16 v[60:63], v[124:127], v[14:17], v[60:63]
    ds_write_b32 v47, v167
    s_cmp_lg_u32 s8, 0
    s_cbranch_scc1 XM2
    s_setprio 1
    s_waitcnt lgkmcnt(2)
    v_mfma_f32_16x16x32_bf16 v[56:59], v[128:131], v[18:21], v[56:59]
    v_mfma_f32_16x16x32_bf16 v[60:63], v[132:135], v[18:21], v[60:63]
XM2:
    s_waitcnt lgkmcnt(5)
    v_mfma_f32_16x16x32_bf16 v[56:59], v[64:67], v[24:27], v[56:59]
    ds_read_b128 v[162:165], v156 offset:3072
    v_add_u32 v167, 1, v167
    v_mfma_f32_16x16x32_bf16 v[60:63], v[96:99], v[24:27], v[60:63]
    ds_read_b128 v[2:5], v153 offset:2432
    s_waitcnt lgkmcnt(6)
    v_mfma_f32_16x16x32_bf16 v[56:59], v[68:71], v[28:31], v[56:59]
    ds_read_b128 v[6:9], v153 offset:2304
    v_mfma_f32_16x16x32_bf16 v[60:63], v[100:103], v[28:31], v[60:63]
    ds_read_b128 v[10:13], v153 offset:2176
    s_waitcnt lgkmcnt(7)
    v_mfma_f32_16x16x32_bf16 v[56:59], v[72:75], v[32:35], v[56:59]
    ds_read_b128 v[14:17], v153 offset:2048
    v_mfma_f32_16x16x32_bf16 v[60:63], v[104:107], v[32:35], v[60:63]
    s_cmp_lg_u32 s8, 1
    s_cbranch_scc1 XL3
    ds_read_b128 v[18:21], v155 offset:1408
    ds_read_b128 v[40:43], v155 offset:384
    ds_read2_b32 v[136:137], v150 offset0:36 offset1:34
    ds_read2_b32 v[138:139], v150 offset0:32 offset1:30
    ds_read2_b32 v[140:141], v23 offset0:36 offset1:34
    ds_read2_b32 v[142:143], v23 offset0:32 offset1:30
XL3:
    s_waitcnt lgkmcnt(7)
    v_mfma_f32_16x16x32_bf16 v[56:59], v[76:79], v[36:39], v[56:59]
    v_mfma_f32_16x16x32_bf16 v[60:63], v[108:111], v[36:39], v[60:63]
    v_mfma_f32_16x16x32_bf16 v[48:51], v[80:83], v[24:27], 0
    v_mfma_f32_16x16x32_bf16 v[52:55], v[112:115], v[24:27], 0
    s_nop 4
    v_mfma_f32_16x16x32_bf16 v[48:51], v[84:87], v[28:31], v[48:51]
    s_waitcnt lgkmcnt(4)
    v_sub_f32 v158, v56, v60
    v_fma_f32 v158, v158, v162, v60
    v_mfma_f32_16x16x32_bf16 v[52:55], v[116:119], v[28:31], v[52:55]
    v_sub_f32 v159, v57, v61
    v_fma_f32 v159, v159, v163, v61
    v_mfma_f32_16x16x32_bf16 v[48:51], v[88:91], v[32:35], v[48:51]
    v_sub_f32 v160, v58, v62
    v_fma_f32 v160, v160, v164, v62
    v_mfma_f32_16x16x32_bf16 v[52:55], v[120:123], v[32:35], v[52:55]
    v_sub_f32 v161, v59, v63
    v_fma_f32 v161, v161, v165, v63
    v_mfma_f32_16x16x32_bf16 v[48:51], v[92:95], v[36:39], v[48:51]
    ds_write_b128 v154, v[158:161] offset:37056
    v_mfma_f32_16x16x32_bf16 v[52:55], v[124:127], v[36:39], v[52:55]
    ds_write_b32 v47, v167
    s_cmp_lg_u32 s8, 1
    s_cbranch_scc1 XM3
    s_setprio 1
    s_waitcnt lgkmcnt(2)
    v_mfma_f32_16x16x32_bf16 v[48:51], v[128:131], v[18:21], v[48:51]
    v_mfma_f32_16x16x32_bf16 v[52:55], v[132:135], v[18:21], v[52:55]
    v_mfma_f32_16x16x32_bf16 v[48:51], v[136:139], v[40:43], v[48:51]
    v_mfma_f32_16x16x32_bf16 v[52:55], v[140:143], v[40:43], v[52:55]
XM3:
    s_waitcnt lgkmcnt(5)
    v_mfma_f32_16x16x32_bf16 v[48:51], v[64:67], v[2:5], v[48:51]
    ds_read_b128 v[162:165], v156 offset:4096
    v_add_u32 v167, 1, v167
    v_mfma_f32_16x16x32_bf16 v[52:55], v[96:99], v[2:5], v[52:55]
    ds_read_b128 v[24:27], v153 offset:2944
    s_waitcnt lgkmcnt(6)
    v_mfma_f32_16x16x32_bf16 v[48:51], v[68:71], v[6:9], v[48:51]
    ds_read_b128 v[28:31], v153 offset:2816
    v_mfma_f32_16x16x32_bf16 v[52:55], v[100:103], v[6:9], v[52:55]
    ds_read_b128 v[32:35], v153 offset:2688
    s_waitcnt lgkmcnt(7)
    v_mfma_f32_16x16x32_bf16 v[48:51], v[72:75], v[10:13], v[48:51]
    ds_read_b128 v[36:39], v153 offset:2560
    v_mfma_f32_16x16x32_bf16 v[52:55], v[104:107], v[10:13], v[52:55]
    s_cmp_lg_u32 s8, 0
    s_cbranch_scc1 XL4
    ds_read_b128 v[18:21], v155 offset:1920
    ds_read_b128 v[40:43], v155 offset:896
    ds_read2_b32 v[136:137], v150 offset0:36 offset1:34
    ds_read2_b32 v[138:139], v150 offset0:32 offset1:30
    ds_read2_b32 v[140:141], v23 offset0:36 offset1:34
    ds_read2_b32 v[142:143], v23 offset0:32 offset1:30
XL4:
    s_waitcnt lgkmcnt(7)
    v_mfma_f32_16x16x32_bf16 v[48:51], v[76:79], v[14:17], v[48:51]
    v_mfma_f32_16x16x32_bf16 v[52:55], v[108:111], v[14:17], v[52:55]
    v_mfma_f32_16x16x32_bf16 v[56:59], v[80:83], v[2:5], 0
    v_mfma_f32_16x16x32_bf16 v[60:63], v[112:115], v[2:5], 0
    s_nop 4
    v_mfma_f32_16x16x32_bf16 v[56:59], v[84:87], v[6:9], v[56:59]
    s_waitcnt lgkmcnt(4)
    v_sub_f32 v158, v48, v52
    v_fma_f32 v158, v158, v162, v52
    v_mfma_f32_16x16x32_bf16 v[60:63], v[116:119], v[6:9], v[60:63]
    v_sub_f32 v159, v49, v53
    v_fma_f32 v159, v159, v163, v53
    v_mfma_f32_16x16x32_bf16 v[56:59], v[88:91], v[10:13], v[56:59]
    v_sub_f32 v160, v50, v54
    v_fma_f32 v160, v160, v164, v54
    v_mfma_f32_16x16x32_bf16 v[60:63], v[120:123], v[10:13], v[60:63]
    v_sub_f32 v161, v51, v55
    v_fma_f32 v161, v161, v165, v55
    v_mfma_f32_16x16x32_bf16 v[56:59], v[92:95], v[14:17], v[56:59]
    ds_write_b128 v154, v[158:161] offset:49408
    v_mfma_f32_16x16x32_bf16 v[60:63], v[124:127], v[14:17], v[60:63]
    ds_write_b32 v47, v167
    s_cmp_lg_u32 s8, 0
    s_cbranch_scc1 XM4
    s_setprio 0
    s_waitcnt lgkmcnt(2)
    v_mfma_f32_16x16x32_bf16 v[56:59], v[128:131], v[18:21], v[56:59]
    v_mfma_f32_16x16x32_bf16 v[60:63], v[132:135], v[18:21], v[60:63]
    v_mfma_f32_16x16x32_bf16 v[56:59], v[136:139], v[40:43], v[56:59]
    v_mfma_f32_16x16x32_bf16 v[60:63], v[140:143], v[40:43], v[60:63]
XM4:
    s_waitcnt lgkmcnt(5)
    v_mfma_f32_16x16x32_bf16 v[56:59], v[64:67], v[24:27], v[56:59]
    ds_read_b128 v[162:165], v156 offset:5120
    v_add_u32 v167, 1, v167
    v_add_u32 v154, 61760, v154
    v_mfma_f32_16x16x32_bf16 v[60:63], v[96:99], v[24:27], v[60:63]
    ds_read_b128 v[2:5], v153 offset:3456
    s_waitcnt lgkmcnt(6)
    v_mfma_f32_16x16x32_bf16 v[56:59], v[68:71], v[28:31], v[56:59]
    ds_read_b128 v[6:9], v153 offset:3328
    v_mfma_f32_16x16x32_bf16 v[60:63], v[100:103], v[28:31], v[60:63]
    ds_read_b128 v[10:13], v153 offset:3200
    s_waitcnt lgkmcnt(7)
    v_mfma_f32_16x16x32_bf16 v[56:59], v[72:75], v[32:35], v[56:59]
    ds_read_b128 v[14:17], v153 offset:3072
    v_mfma_f32_16x16x32_bf16 v[60:63], v[104:107], v[32:35], v[60:63]
    s_cmp_lg_u32 s8, 1
    s_cbranch_scc1 XL5
    ds_read_b128 v[18:21], v155 offset:2432
    ds_read_b128 v[40:43], v155 offset:1408
XL5:
    s_waitcnt lgkmcnt(7)
    v_mfma_f32_16x16x32_bf16 v[56:59], v[76:79], v[36:39], v[56:59]
    v_mfma_f32_16x16x32_bf16 v[60:63], v[108:111], v[36:39], v[60:63]
    v_mfma_f32_16x16x32_bf16 v[48:51], v[80:83], v[24:27], 0
    v_mfma_f32_16x16x32_bf16 v[52:55], v[112:115], v[24:27], 0
    s_nop 4
    v_mfma_f32_16x16x32_bf16 v[48:51], v[84:87], v[28:31], v[48:51]
    s_waitcnt lgkmcnt(4)
    v_sub_f32 v158, v56, v60
    v_fma_f32 v158, v158, v162, v60
    v_mfma_f32_16x16x32_bf16 v[52:55], v[116:119], v[28:31], v[52:55]
    v_sub_f32 v159, v57, v61
    v_fma_f32 v159, v159, v163, v61
    v_mfma_f32_16x16x32_bf16 v[48:51], v[88:91], v[32:35], v[48:51]
    v_sub_f32 v160, v58, v62
    v_fma_f32 v160, v160, v164, v62
    v_mfma_f32_16x16x32_bf16 v[52:55], v[120:123], v[32:35], v[52:55]
    v_sub_f32 v161, v59, v63
    v_fma_f32 v161, v161, v165, v63
    v_mfma_f32_16x16x32_bf16 v[48:51], v[92:95], v[36:39], v[48:51]
    ds_write_b128 v154, v[158:161] offset:0
    v_mfma_f32_16x16x32_bf16 v[52:55], v[124:127], v[36:39], v[52:55]
    ds_write_b32 v47, v167
    s_cmp_lg_u32 s8, 1
    s_cbranch_scc1 XM5
    s_setprio 0
    s_waitcnt lgkmcnt(2)
    v_mfma_f32_16x16x32_bf16 v[48:51], v[128:131], v[18:21], v[48:51]
    v_mfma_f32_16x16x32_bf16 v[52:55], v[132:135], v[18:21], v[52:55]
    v_mfma_f32_16x16x32_bf16 v[48:51], v[136:139], v[40:43], v[48:51]
    v_mfma_f32_16x16x32_bf16 v[52:55], v[140:143], v[40:43], v[52:55]
XM5:
    s_waitcnt lgkmcnt(5)
    v_mfma_f32_16x16x32_bf16 v[48:51], v[64:67], v[2:5], v[48:51]
    ds_read_b128 v[162:165], v156 offset:6144
    v_add_u32 v167, 1, v167
    v_mfma_f32_16x16x32_bf16 v[52:55], v[96:99], v[2:5], v[52:55]
    ds_read_b128 v[24:27], v153 offset:3968
    s_waitcnt lgkmcnt(6)
    v_mfma_f32_16x16x32_bf16 v[48:51], v[68:71], v[6:9], v[48:51]
    ds_read_b128 v[28:31], v153 offset:3840
    v_mfma_f32_16x16x32_bf16 v[52:55], v[100:103], v[6:9], v[52:55]
    ds_read_b128 v[32:35], v153 offset:3712
    s_waitcnt lgkmcnt(7)
    v_mfma_f32_16x16x32_bf16 v[48:51], v[72:75], v[10:13], v[48:51]
    ds_read_b128 v[36:39], v153 offset:3584
    v_mfma_f32_16x16x32_bf16 v[52:55], v[104:107], v[10:13], v[52:55]
    s_cmp_lg_u32 s8, 0
    s_cbranch_scc1 XL6
    ds_read_b128 v[18:21], v155 offset:2944
    ds_read_b128 v[40:43], v155 offset:1920
XL6:
    s_waitcnt lgkmcnt(7)
    v_mfma_f32_16x16x32_bf16 v[48:51], v[76:79], v[14:17], v[48:51]
    v_mfma_f32_16x16x32_bf16 v[52:55], v[108:111], v[14:17], v[52:55]
    v_mfma_f32_16x16x32_bf16 v[56:59], v[80:83], v[2:5], 0
    v_mfma_f32_16x16x32_bf16 v[60:63], v[112:115], v[2:5], 0
    s_nop 4
    v_mfma_f32_16x16x32_bf16 v[56:59], v[84:87], v[6:9], v[56:59]
    s_waitcnt lgkmcnt(4)
    v_sub_f32 v158, v48, v52
    v_fma_f32 v158, v158, v162, v52
    v_mfma_f32_16x16x32_bf16 v[60:63], v[116:119], v[6:9], v[60:63]
    v_sub_f32 v159, v49, v53
    v_fma_f32 v159, v159, v163, v53
    v_mfma_f32_16x16x32_bf16 v[56:59], v[88:91], v[10:13], v[56:59]
    v_sub_f32 v160, v50, v54
    v_fma_f32 v160, v160, v164, v54
    v_mfma_f32_16x16x32_bf16 v[60:63], v[120:123], v[10:13], v[60:63]
    v_sub_f32 v161, v51, v55
    v_fma_f32 v161, v161, v165, v55
    v_mfma_f32_16x16x32_bf16 v[56:59], v[92:95], v[14:17], v[56:59]
    ds_write_b128 v154, v[158:161] offset:12352
    v_mfma_f32_16x16x32_bf16 v[60:63], v[124:127], v[14:17], v[60:63]
    ds_write_b32 v47, v167
    s_cmp_lg_u32 s8, 0
    s_cbranch_scc1 XM6
    s_waitcnt lgkmcnt(2)
    v_mfma_f32_16x16x32_bf16 v[56:59], v[128:131], v[18:21], v[56:59]
    v_mfma_f32_16x16x32_bf16 v[60:63], v[132:135], v[18:21], v[60:63]
    v_mfma_f32_16x16x32_bf16 v[56:59], v[136:139], v[40:43], v[56:59]
    v_mfma_f32_16x16x32_bf16 v[60:63], v[140:143], v[40:43], v[60:63]
XM6:
    s_waitcnt lgkmcnt(5)
    v_mfma_f32_16x16x32_bf16 v[56:59], v[64:67], v[24:27], v[56:59]
    ds_read_b128 v[162:165], v156 offset:7168
    v_mfma_f32_16x16x32_bf16 v[60:63], v[96:99], v[24:27], v[60:63]
    v_add_u32 v167, 1, v167
    s_waitcnt lgkmcnt(5)
    v_mfma_f32_16x16x32_bf16 v[56:59], v[68:71], v[28:31], v[56:59]
    v_mfma_f32_16x16x32_bf16 v[60:63], v[100:103], v[28:31], v[60:63]
    s_waitcnt lgkmcnt(4)
    v_mfma_f32_16x16x32_bf16 v[56:59], v[72:75], v[32:35], v[56:59]
    v_mfma_f32_16x16x32_bf16 v[60:63], v[104:107], v[32:35], v[60:63]
    s_waitcnt lgkmcnt(3)
    v_mfma_f32_16x16x32_bf16 v[56:59], v[76:79], v[36:39], v[56:59]
    v_mfma_f32_16x16x32_bf16 v[60:63], v[108:111], v[36:39], v[60:63]
    s_nop 7
    s_waitcnt lgkmcnt(0)
    v_sub_f32 v158, v56, v60
    v_fma_f32 v158, v158, v162, v60
    v_sub_f32 v159, v57, v61
    v_fma_f32 v159, v159, v163, v61
    v_sub_f32 v160, v58, v62
    v_fma_f32 v160, v160, v164, v62
    v_sub_f32 v161, v59, v63
    v_fma_f32 v161, v161, v165, v63
    ds_write_b128 v154, v[158:161] offset:24704
    ds_write_b32 v47, v167
    s_branch FIN
FIRST_X:
    v_mov_b32 v24, v139
    v_mov_b32 v25, v139
    v_and_b32 v26, 0xffff0000, v139
    v_mov_b32 v27, 0
    s_mov_b32 exec_lo, 0
    s_brev_b32 exec_hi, 1
    ds_write_b128 v144, v[24:27] offset:32
    s_mov_b64 exec, -1
    ds_write_b32 v47, v167
    s_setprio 0
    v_fma_f32 v140, v60, v20, v140
    v_fma_f32 v141, v61, v20, v141
    v_fma_f32 v142, v62, v20, v142
    v_fma_f32 v143, v63, v20, v143
    v_cvt_pk_bf16_f32 v140, v140, v141
    v_cvt_pk_bf16_f32 v141, v142, v143
    ds_write_b32 v145, v140
    ds_write_b16 v146, v141
    ds_write_b16_d16_hi v146, v141 offset:128
    v_mov_b32 v167, 7
    ds_write_b32 v47, v167
    v_lshrrev_b32 v32, 16, v140
    v_and_b32 v34, 0xffff0000, v140
    v_or_b32 v33, v32, v34
    v_mov_b32 v35, 0
    s_mov_b32 exec_lo, 0
    s_brev_b32 exec_hi, 1
    ds_write_b128 v144, v[32:35] offset:160
    s_mov_b64 exec, -1
    ds_read2_b32 v[64:65], v148 offset0:6 offset1:4
    ds_read2_b32 v[66:67], v148 offset0:2 offset1:0
    ds_read2_b32 v[68:69], v148 offset0:70 offset1:68
    ds_read2_b32 v[70:71], v148 offset0:66 offset1:64
    ds_read2_b32 v[72:73], v148 offset0:134 offset1:132
    ds_read2_b32 v[74:75], v148 offset0:130 offset1:128
    ds_read2_b32 v[76:77], v148 offset0:198 offset1:196
    ds_read2_b32 v[78:79], v148 offset0:194 offset1:192
    ds_read2_b32 v[80:81], v149 offset0:6 offset1:4
    ds_read2_b32 v[82:83], v149 offset0:2 offset1:0
    ds_read2_b32 v[84:85], v149 offset0:70 offset1:68
    ds_read2_b32 v[86:87], v149 offset0:66 offset1:64
    ds_read2_b32 v[88:89], v149 offset0:134 offset1:132
    ds_read2_b32 v[90:91], v149 offset0:130 offset1:128
    ds_read2_b32 v[92:93], v149 offset0:198 offset1:196
    ds_read2_b32 v[94:95], v149 offset0:194 offset1:192
    s_mov_b32 s1, 0
POLL_5:
    ds_read_b32 v28, v46
    s_waitcnt lgkmcnt(0)
    v_cmp_le_u32 vcc, 6, v28
    s_andn2_b32 s12, 0x400, vcc_lo
    s_cbranch_scc0 POLL_5_X
    s_sleep 1
    s_add_u32 s1, s1, 1
    s_cmp_lt_u32 s1, 0x8000
    s_cbranch_scc1 POLL_5
POLL_5_X:
    ds_read_b128 v[2:5], v153 offset:384
    ds_read_b128 v[6:9], v153 offset:256
    ds_read_b128 v[10:13], v153 offset:128
    ds_read_b128 v[14:17], v153 offset:0
    s_mov_b32 s1, 0
POLL_6:
    ds_read_b32 v28, v46
    s_waitcnt lgkmcnt(0)
    v_cmp_le_u32 vcc, 6, v28
    s_andn2_b32 s12, s58, vcc_lo
    s_cbranch_scc0 POLL_6_X
    s_sleep 1
    s_add_u32 s1, s1, 1
    s_cmp_lt_u32 s1, 0x8000
    s_cbranch_scc1 POLL_6
POLL_6_X:
    s_setprio 3
    s_andn2_b32 s79, 0x2000, vcc_lo
    ds_read_b128 v[162:165], v156 offset:0
    ds_read2_b32 v[96:97], v151 offset0:6 offset1:4
    ds_read2_b32 v[98:99], v151 offset0:2 offset1:0
    ds_read2_b32 v[100:101], v151 offset0:70 offset1:68
    ds_read2_b32 v[102:103], v151 offset0:66 offset1:64
    ds_read2_b32 v[104:105], v151 offset0:134 offset1:132
    ds_read2_b32 v[106:107], v151 offset0:130 offset1:128
    ds_read2_b32 v[108:109], v151 offset0:198 offset1:196
    ds_read2_b32 v[110:111], v151 offset0:194 offset1:192
    s_branch FIRST_GO
FIRST_Y:
    s_mov_b32 s1, 0
POLL_7:
    ds_read_b32 v28, v46
    s_waitcnt lgkmcnt(0)
    v_cmp_le_u32 vcc, 6, v28
    s_andn2_b32 s12, s58, vcc_lo
    s_cbranch_scc0 POLL_7_X
    s_sleep 1
    s_add_u32 s1, s1, 1
    s_cmp_lt_u32 s1, 0x8000
    s_cbranch_scc1 POLL_7
POLL_7_X:
    s_andn2_b32 s79, 0x2000, vcc_lo
    ds_read_b128 v[2:5], v153 offset:384
    ds_read_b128 v[6:9], v153 offset:256
    ds_read_b128 v[10:13], v153 offset:128
    ds_read_b128 v[14:17], v153 offset:0
    ds_read_b128 v[162:165], v156 offset:0
    ds_read2_b32 v[64:65], v148 offset0:6 offset1:4
    ds_read2_b32 v[66:67], v148 offset0:2 offset1:0
    ds_read2_b32 v[68:69], v148 offset0:70 offset1:68
    ds_read2_b32 v[70:71], v148 offset0:66 offset1:64
    ds_read2_b32 v[72:73], v148 offset0:134 offset1:132
    ds_read2_b32 v[74:75], v148 offset0:130 offset1:128
    ds_read2_b32 v[76:77], v148 offset0:198 offset1:196
    ds_read2_b32 v[78:79], v148 offset0:194 offset1:192
    ds_read2_b32 v[80:81], v149 offset0:6 offset1:4
    ds_read2_b32 v[82:83], v149 offset0:2 offset1:0
    ds_read2_b32 v[84:85], v149 offset0:70 offset1:68
    ds_read2_b32 v[86:87], v149 offset0:66 offset1:64
    ds_read2_b32 v[88:89], v149 offset0:134 offset1:132
    ds_read2_b32 v[90:91], v149 offset0:130 offset1:128
    ds_read2_b32 v[92:93], v149 offset0:198 offset1:196
    ds_read2_b32 v[94:95], v149 offset0:194 offset1:192
    s_waitcnt lgkmcnt(8)
    s_branch FIRST_GO
G_SLOW:
    s_mov_b32 s1, 0
POLL_8:
    ds_read_b32 v28, v46
    s_waitcnt lgkmcnt(0)
    v_cmp_le_u32 vcc, 6, v28
    s_andn2_b32 s12, 0x2000, vcc_lo
    s_cbranch_scc0 POLL_8_X
    s_sleep 1
    s_add_u32 s1, s1, 1
    s_cmp_lt_u32 s1, 0x8000
    s_cbranch_scc1 POLL_8
POLL_8_X:
    ds_read_b128 v[162:165], v156 offset:0
    s_waitcnt lgkmcnt(0)
    s_branch G_GO
ONEW:
    s_cmp_eq_u32 s3, 3
    s_cselect_b32 s12, 1, 0
    s_cmp_eq_u32 s78, 0
    s_cselect_b32 s12, s12, 0
    s_cmp_eq_u32 s12, 1
    s_cselect_b32 s13, 2560, s76
    s_mov_b32 s78, 2
    v_add_u32 v21, s13, v45
    s_cselect_b32 s12, 1, 9
    v_mov_b32 v28, s12
    v_mov_b32 v14, v6
    v_mul_f32 v49, v49, v20
    ds_write_b128 v21, v[48:51]
    v_mul_f32 v52, v52, v20
    v_mul_f32 v53, v53, v20
    v_mul_f32 v54, v54, v20
    v_mul_f32 v55, v55, v20
    ds_write_b128 v21, v[52:55] offset:12352
    v_mul_f32 v56, v56, v20
    v_mul_f32 v57, v57, v20
    v_mul_f32 v58, v58, v20
    v_mul_f32 v59, v59, v20
    ds_write_b128 v21, v[56:59] offset:24704
    v_mul_f32 v60, v60, v20
    v_mul_f32 v61, v61, v20
    v_mul_f32 v62, v62, v20
    v_mul_f32 v63, v63, v20
    ds_write_b128 v21, v[60:63] offset:37056
    ds_write_b32 v47, v28
    s_cbranch_scc0 ONEW2
    s_mov_b32 s10, 1
    s_mov_b32 s14, 0xbfb8aa3b
    s_mov_b32 s15, 0x3b000000
    v_mov_b32 v48, 0
    v_mov_b32 v49, 0
    v_mov_b32 v50, 0
    v_mov_b32 v51, 0
    v_mov_b32 v52, 0
    v_mov_b32 v53, 0
    v_mov_b32 v54, 0
    v_mov_b32 v55, 0
    v_mov_b32 v56, 0
    v_mov_b32 v57, 0
    v_mov_b32 v58, 0
    v_mov_b32 v59, 0
    v_mov_b32 v60, 0
    v_mov_b32 v61, 0
    v_mov_b32 v62, 0
    v_mov_b32 v63, 0
    s_branch KG_CONST
ONEW2:
    s_setprio 0
    s_cmp_lg_u32 s7, 3
    s_cbranch_scc1 HELPER
    v_and_b32 v6, 15, v0
    v_lshrrev_b32 v7, 4, v0
    s_mul_i32 s13, s8, 4608
    s_add_u32 s13, s13, 99280
    v_lshl_add_u32 v2, v6, 5, s13
    v_lshl_add_u32 v2, v7, 4, v2
    s_mul_i32 s14, s8, 6144
    s_add_u32 s13, s14, 115000
    v_lshl_add_u32 v3, v6, 3, s13
    v_lshlrev_b32 v4, 5, v7
    v_sub_u32 v3, v3, v4
    s_add_u32 s13, s14, 115396
    v_lshlrev_b32 v4, 2, v7
    v_sub_u32 v4, v6, v4
    v_lshl_add_u32 v4, v4, 2, s13
    v_add_u32 v44, 3072, v4
    v_add_u32 v5, s8, v6
    v_and_b32 v5, 3, v5
    v_lshl_add_u32 v5, v5, 2, v7
    v_lshrrev_b32 v7, 2, v6
    v_mul_u32_u24 v7, 3088, v7
    v_lshl_add_u32 v5, v5, 4, v7
    s_add_u32 s13, s76, 24704
    v_add_u32 v5, s13, v5
    s_lshl_b32 s56, 1, s8
    s_lshl_b32 s13, s8, 3
    s_lshr_b32 s57, 0x502050, s13
    s_and_b32 s57, s57, 0xff
    s_or_b32 s57, s57, 0x2000
    v_lshlrev_b32 v45, 4, v0
    v_add_u32 v45, 131136, v45
    s_mov_b32 s1, 0
POLL_9:
    ds_read_b32 v6, v46
    s_waitcnt lgkmcnt(0)
    v_cmp_le_u32 vcc, 2, v6
    s_andn2_b32 s12, 0x400, vcc_lo
    s_cbranch_scc0 POLL_9_X
    s_sleep 4
    s_add_u32 s1, s1, 1
    s_cmp_lt_u32 s1, 0x8000
    s_cbranch_scc1 POLL_9
POLL_9_X:
    s_setprio 2
    ds_read_b128 v[8:11], v2 offset:16
    ds_read_b128 v[12:15], v2 offset:0
    ds_read_b128 v[16:19], v2 offset:528
    ds_read_b128 v[20:23], v2 offset:512
    s_waitcnt lgkmcnt(2)
    v_mfma_f32_16x16x32_bf16 v[24:27], v[8:11], v[144:147], 0
    v_mfma_f32_16x16x32_bf16 v[28:31], v[8:11], v[148:151], 0
    v_mfma_f32_16x16x32_bf16 v[32:35], v[12:15], v[144:147], 0
    v_mfma_f32_16x16x32_bf16 v[36:39], v[12:15], v[148:151], 0
    v_mfma_f32_16x16x32_bf16 v[40:43], v[8:11], v[152:155], 0
    v_mfma_f32_16x16x32_bf16 v[128:131], v[12:15], v[156:159], 0
    s_mov_b32 s1, 0
POLL_10:
    ds_read_b32 v6, v46
    s_waitcnt lgkmcnt(0)
    v_cmp_le_u32 vcc, 7, v6
    s_andn2_b32 s12, 0x400, vcc_lo
    s_cbranch_scc0 POLL_10_X
    s_sleep 4
    s_add_u32 s1, s1, 1
    s_cmp_lt_u32 s1, 0x8000
    s_cbranch_scc1 POLL_10
POLL_10_X:
    ds_read_b128 v[8:11], v2 offset:1040
    ds_read_b128 v[12:15], v2 offset:1024
    s_waitcnt lgkmcnt(2)
    v_mfma_f32_16x16x32_bf16 v[48:51], v[16:19], v[144:147], 0
    v_cvt_pk_bf16_f32 v64, v27, v31
    v_cvt_pk_bf16_f32 v66, v26, v30
    v_mfma_f32_16x16x32_bf16 v[52:55], v[16:19], v[148:151], 0
    v_cvt_pk_bf16_f32 v68, v25, v29
    v_cvt_pk_bf16_f32 v70, v24, v28
    v_mfma_f32_16x16x32_bf16 v[56:59], v[20:23], v[144:147], 0
    v_cvt_pk_bf16_f32 v65, v35, v39
    v_cvt_pk_bf16_f32 v67, v34, v38
    v_mfma_f32_16x16x32_bf16 v[60:63], v[20:23], v[148:151], 0
    v_cvt_pk_bf16_f32 v69, v33, v37
    v_cvt_pk_bf16_f32 v71, v32, v36
    v_mfma_f32_16x16x32_bf16 v[132:135], v[16:19], v[152:155], 0
    v_cvt_pk_bf16_f32 v112, v43, v131
    v_cvt_pk_bf16_f32 v113, v42, v130
    v_mfma_f32_16x16x32_bf16 v[136:139], v[20:23], v[156:159], 0
    v_cvt_pk_bf16_f32 v114, v41, v129
    v_cvt_pk_bf16_f32 v115, v40, v128
    ds_read_b128 v[16:19], v2 offset:1552
    ds_read_b128 v[20:23], v2 offset:1536
    s_waitcnt lgkmcnt(2)
    v_mfma_f32_16x16x32_bf16 v[24:27], v[8:11], v[144:147], 0
    v_cvt_pk_bf16_f32 v72, v51, v55
    v_cvt_pk_bf16_f32 v74, v50, v54
    v_mfma_f32_16x16x32_bf16 v[28:31], v[8:11], v[148:151], 0
    v_cvt_pk_bf16_f32 v76, v49, v53
    v_cvt_pk_bf16_f32 v78, v48, v52
    v_mfma_f32_16x16x32_bf16 v[32:35], v[12:15], v[144:147], 0
    v_cvt_pk_bf16_f32 v73, v59, v63
    v_cvt_pk_bf16_f32 v75, v58, v62
    v_mfma_f32_16x16x32_bf16 v[36:39], v[12:15], v[148:151], 0
    v_cvt_pk_bf16_f32 v77, v57, v61
    v_cvt_pk_bf16_f32 v79, v56, v60
    v_mfma_f32_16x16x32_bf16 v[40:43], v[8:11], v[152:155], 0
    v_cvt_pk_bf16_f32 v116, v135, v139
    v_cvt_pk_bf16_f32 v117, v134, v138
    v_mfma_f32_16x16x32_bf16 v[128:131], v[12:15], v[156:159], 0
    v_cvt_pk_bf16_f32 v118, v133, v137
    v_cvt_pk_bf16_f32 v119, v132, v136
    s_mov_b32 s1, 0
POLL_11:
    ds_read_b32 v6, v46
    s_waitcnt lgkmcnt(0)
    v_cmp_le_u32 vcc, 8, v6
    s_andn2_b32 s12, 0x400, vcc_lo
    s_cbranch_scc0 POLL_11_X
    s_sleep 4
    s_add_u32 s1, s1, 1
    s_cmp_lt_u32 s1, 0x8000
    s_cbranch_scc1 POLL_11
POLL_11_X:
    ds_read_b128 v[8:11], v2 offset:2064
    ds_read_b128 v[12:15], v2 offset:2048
    s_waitcnt lgkmcnt(2)
    v_mfma_f32_16x16x32_bf16 v[48:51], v[16:19], v[144:147], 0
    v_cvt_pk_bf16_f32 v80, v27, v31
    v_cvt_pk_bf16_f32 v82, v26, v30
    v_mfma_f32_16x16x32_bf16 v[52:55], v[16:19], v[148:151], 0
    v_cvt_pk_bf16_f32 v84, v25, v29
    v_cvt_pk_bf16_f32 v86, v24, v28
    v_mfma_f32_16x16x32_bf16 v[56:59], v[20:23], v[144:147], 0
    v_cvt_pk_bf16_f32 v81, v35, v39
    v_cvt_pk_bf16_f32 v83, v34, v38
    v_mfma_f32_16x16x32_bf16 v[60:63], v[20:23], v[148:151], 0
    v_cvt_pk_bf16_f32 v85, v33, v37
    v_cvt_pk_bf16_f32 v87, v32, v36
    v_mfma_f32_16x16x32_bf16 v[132:135], v[16:19], v[152:155], 0
    v_cvt_pk_bf16_f32 v120, v43, v131
    v_cvt_pk_bf16_f32 v121, v42, v130
    v_mfma_f32_16x16x32_bf16 v[136:139], v[20:23], v[156:159], 0
    v_cvt_pk_bf16_f32 v122, v41, v129
    v_cvt_pk_bf16_f32 v123, v40, v128
    ds_read_b128 v[16:19], v2 offset:2576
    ds_read_b128 v[20:23], v2 offset:2560
    s_waitcnt lgkmcnt(2)
    v_mfma_f32_16x16x32_bf16 v[24:27], v[8:11], v[144:147], 0
    v_cvt_pk_bf16_f32 v88, v51, v55
    v_cvt_pk_bf16_f32 v90, v50, v54
    v_cvt_pk_bf16_f32 v92, v49, v53
    v_mfma_f32_16x16x32_bf16 v[28:31], v[8:11], v[148:151], 0
    v_cvt_pk_bf16_f32 v94, v48, v52
    v_cvt_pk_bf16_f32 v89, v59, v63
    v_cvt_pk_bf16_f32 v91, v58, v62
    v_mfma_f32_16x16x32_bf16 v[32:35], v[12:15], v[144:147], 0
    v_cvt_pk_bf16_f32 v93, v57, v61
    v_cvt_pk_bf16_f32 v95, v56, v60
    v_cvt_pk_bf16_f32 v124, v135, v139
    v_mfma_f32_16x16x32_bf16 v[36:39], v[12:15], v[148:151], 0
    v_cvt_pk_bf16_f32 v125, v134, v138
    v_cvt_pk_bf16_f32 v126, v133, v137
    v_cvt_pk_bf16_f32 v127, v132, v136
    s_waitcnt lgkmcnt(0)
    v_mfma_f32_16x16x32_bf16 v[48:51], v[16:19], v[144:147], 0
    v_cvt_pk_bf16_f32 v96, v27, v31
    v_cvt_pk_bf16_f32 v98, v26, v30
    v_mfma_f32_16x16x32_bf16 v[52:55], v[16:19], v[148:151], 0
    v_cvt_pk_bf16_f32 v100, v25, v29
    v_cvt_pk_bf16_f32 v102, v24, v28
    v_mfma_f32_16x16x32_bf16 v[56:59], v[20:23], v[144:147], 0
    v_cvt_pk_bf16_f32 v97, v35, v39
    v_cvt_pk_bf16_f32 v99, v34, v38
    v_mfma_f32_16x16x32_bf16 v[60:63], v[20:23], v[148:151], 0
    v_cvt_pk_bf16_f32 v101, v33, v37
    v_cvt_pk_bf16_f32 v103, v32, v36
    s_nop 1
    v_cvt_pk_bf16_f32 v104, v51, v55
    v_cvt_pk_bf16_f32 v106, v50, v54
    v_cvt_pk_bf16_f32 v108, v49, v53
    v_cvt_pk_bf16_f32 v110, v48, v52
    v_cvt_pk_bf16_f32 v105, v59, v63
    v_cvt_pk_bf16_f32 v107, v58, v62
    v_cvt_pk_bf16_f32 v109, v57, v61
    v_cvt_pk_bf16_f32 v111, v56, v60
    s_mov_b32 s1, 0
POLL_12:
    ds_read_b32 v6, v46
    s_waitcnt lgkmcnt(0)
    v_cmp_le_u32 vcc, 7, v6
    s_andn2_b32 s12, s56, vcc_lo
    s_cbranch_scc0 POLL_12_X
    s_sleep 2
    s_add_u32 s1, s1, 1
    s_cmp_lt_u32 s1, 0x8000
    s_cbranch_scc1 POLL_12
POLL_12_X:
    ds_read_b64 v[8:9], v3 offset:0
    ds_read_b64 v[10:11], v3 offset:8
    ds_read_b64 v[12:13], v3 offset:16
    ds_read_b64 v[14:15], v3 offset:24
    ds_read_b64 v[16:17], v3 offset:128
    ds_read_b64 v[18:19], v3 offset:136
    ds_read_b64 v[20:21], v3 offset:144
    ds_read_b64 v[22:23], v3 offset:152
    s_waitcnt lgkmcnt(6)
    v_mfma_f32_16x16x32_bf16 v[56:59], v[64:67], v[8:11], 0
    ds_read_b64 v[24:25], v3 offset:256
    ds_read_b64 v[26:27], v3 offset:264
    s_waitcnt lgkmcnt(6)
    v_mfma_f32_16x16x32_bf16 v[56:59], v[68:71], v[12:15], v[56:59]
    ds_read_b64 v[28:29], v3 offset:272
    ds_read_b64 v[30:31], v3 offset:280
    v_mfma_f32_16x16x32_bf16 v[48:51], v[72:75], v[8:11], 0
    ds_read2_b32 v[144:145], v4 offset0:0 offset1:1
    ds_read2_b32 v[146:147], v4 offset0:2 offset1:3
    v_mfma_f32_16x16x32_bf16 v[48:51], v[76:79], v[12:15], v[48:51]
    ds_read2_b32 v[152:153], v4 offset0:16 offset1:17
    ds_read2_b32 v[154:155], v4 offset0:18 offset1:19
    s_waitcnt lgkmcnt(10)
    v_mfma_f32_16x16x32_bf16 v[48:51], v[64:67], v[16:19], v[48:51]
    s_waitcnt lgkmcnt(8)
    v_mfma_f32_16x16x32_bf16 v[48:51], v[68:71], v[20:23], v[48:51]
    v_mfma_f32_16x16x32_bf16 v[52:55], v[80:83], v[8:11], 0
    v_mfma_f32_16x16x32_bf16 v[52:55], v[84:87], v[12:15], v[52:55]
    v_mfma_f32_16x16x32_bf16 v[52:55], v[72:75], v[16:19], v[52:55]
    v_mfma_f32_16x16x32_bf16 v[52:55], v[76:79], v[20:23], v[52:55]
    s_waitcnt lgkmcnt(6)
    v_mfma_f32_16x16x32_bf16 v[52:55], v[64:67], v[24:27], v[52:55]
    s_waitcnt lgkmcnt(4)
    v_mfma_f32_16x16x32_bf16 v[52:55], v[68:71], v[28:31], v[52:55]
    s_waitcnt lgkmcnt(2)
    v_mfma_f32_16x16x32_bf16 v[52:55], v[112:115], v[144:147], v[52:55]
    s_mov_b32 s1, 0
POLL_13:
    ds_read_b32 v6, v46
    s_waitcnt lgkmcnt(0)
    v_cmp_le_u32 vcc, 7, v6
    s_andn2_b32 s12, s57, vcc_lo
    s_cbranch_scc0 POLL_13_X
    s_sleep 1
    s_add_u32 s1, s1, 1
    s_cmp_lt_u32 s1, 0x8000
    s_cbranch_scc1 POLL_13
POLL_13_X:
    ds_read_b64 v[32:33], v3 offset:3072
    ds_read_b64 v[34:35], v3 offset:3080
    ds_read_b64 v[36:37], v3 offset:3088
    ds_read_b64 v[38:39], v3 offset:3096
    ds_read_b64 v[40:41], v3 offset:3200
    ds_read_b64 v[42:43], v3 offset:3208
    ds_read_b64 v[128:129], v3 offset:3216
    ds_read_b64 v[130:131], v3 offset:3224
    ds_read_b128 v[160:163], v45 offset:2048
    s_waitcnt lgkmcnt(7)
    v_mfma_f32_16x16x32_bf16 v[60:63], v[64:67], v[32:35], 0
    ds_read_b64 v[132:133], v3 offset:3328
    ds_read_b64 v[134:135], v3 offset:3336
    s_waitcnt lgkmcnt(7)
    v_mfma_f32_16x16x32_bf16 v[60:63], v[68:71], v[36:39], v[60:63]
    ds_read_b64 v[136:137], v3 offset:3344
    ds_read_b64 v[138:139], v3 offset:3352
    v_mfma_f32_16x16x32_bf16 v[140:143], v[72:75], v[32:35], 0
    ds_read2_b32 v[148:149], v44 offset0:0 offset1:1
    ds_read2_b32 v[150:151], v44 offset0:2 offset1:3
    v_mfma_f32_16x16x32_bf16 v[140:143], v[76:79], v[36:39], v[140:143]
    ds_read_b128 v[164:167], v45 offset:3072
    s_waitcnt lgkmcnt(10)
    v_mfma_f32_16x16x32_bf16 v[140:143], v[64:67], v[40:43], v[140:143]
    ds_read2_b32 v[156:157], v44 offset0:16 offset1:17
    ds_read2_b32 v[158:159], v44 offset0:18 offset1:19
    s_waitcnt lgkmcnt(10)
    v_mfma_f32_16x16x32_bf16 v[140:143], v[68:71], v[128:131], v[140:143]
    v_sub_f32 v56, v56, v60
    v_sub_f32 v57, v57, v61
    v_sub_f32 v58, v58, v62
    v_sub_f32 v59, v59, v63
    s_waitcnt lgkmcnt(9)
    v_fma_f32 v160, v56, v160, v60
    v_fma_f32 v161, v57, v161, v61
    v_fma_f32 v162, v58, v162, v62
    v_fma_f32 v163, v59, v163, v63
    v_mov_b32 v6, 10
    ds_write_b128 v5, v[160:163] offset:0
    ds_write_b32 v47, v6
    v_mfma_f32_16x16x32_bf16 v[60:63], v[80:83], v[32:35], 0
    ds_read_b128 v[160:163], v45 offset:4096
    v_mfma_f32_16x16x32_bf16 v[60:63], v[84:87], v[36:39], v[60:63]
    v_sub_f32 v48, v48, v140
    v_sub_f32 v49, v49, v141
    v_mfma_f32_16x16x32_bf16 v[60:63], v[72:75], v[40:43], v[60:63]
    v_sub_f32 v50, v50, v142
    v_sub_f32 v51, v51, v143
    v_mfma_f32_16x16x32_bf16 v[60:63], v[76:79], v[128:131], v[60:63]
    s_waitcnt lgkmcnt(5)
    v_fma_f32 v164, v48, v164, v140
    v_fma_f32 v165, v49, v165, v141
    v_mfma_f32_16x16x32_bf16 v[60:63], v[64:67], v[132:135], v[60:63]
    v_fma_f32 v166, v50, v166, v142
    v_fma_f32 v167, v51, v167, v143
    v_mfma_f32_16x16x32_bf16 v[60:63], v[68:71], v[136:139], v[60:63]
    v_mov_b32 v6, 11
    ds_write_b128 v5, v[164:167] offset:12352
    v_mfma_f32_16x16x32_bf16 v[60:63], v[112:115], v[148:151], v[60:63]
    ds_write_b32 v47, v6
    s_setprio 1
    v_mfma_f32_16x16x32_bf16 v[56:59], v[88:91], v[8:11], 0
    ds_read_b128 v[164:167], v45 offset:5120
    v_mfma_f32_16x16x32_bf16 v[56:59], v[92:95], v[12:15], v[56:59]
    ds_read2_b32 v[64:65], v4 offset0:32 offset1:33
    ds_read2_b32 v[66:67], v4 offset0:34 offset1:35
    v_mfma_f32_16x16x32_bf16 v[56:59], v[80:83], v[16:19], v[56:59]
    ds_read2_b32 v[68:69], v44 offset0:32 offset1:33
    ds_read2_b32 v[70:71], v44 offset0:34 offset1:35
    v_mfma_f32_16x16x32_bf16 v[56:59], v[84:87], v[20:23], v[56:59]
    v_mfma_f32_16x16x32_bf16 v[56:59], v[72:75], v[24:27], v[56:59]
    v_sub_f32 v52, v52, v60
    v_sub_f32 v53, v53, v61
    v_mfma_f32_16x16x32_bf16 v[56:59], v[76:79], v[28:31], v[56:59]
    v_sub_f32 v54, v54, v62
    v_sub_f32 v55, v55, v63
    v_mfma_f32_16x16x32_bf16 v[56:59], v[116:119], v[144:147], v[56:59]
    s_waitcnt lgkmcnt(7)
    v_fma_f32 v160, v52, v160, v60
    v_fma_f32 v161, v53, v161, v61
    v_mfma_f32_16x16x32_bf16 v[56:59], v[112:115], v[152:155], v[56:59]
    v_fma_f32 v162, v54, v162, v62
    v_fma_f32 v163, v55, v163, v63
    v_mfma_f32_16x16x32_bf16 v[140:143], v[88:91], v[32:35], 0
    v_mov_b32 v6, 12
    ds_write_b128 v5, v[160:163] offset:24704
    v_mfma_f32_16x16x32_bf16 v[140:143], v[92:95], v[36:39], v[140:143]
    ds_write_b32 v47, v6
    v_mfma_f32_16x16x32_bf16 v[140:143], v[80:83], v[40:43], v[140:143]
    v_mfma_f32_16x16x32_bf16 v[140:143], v[84:87], v[128:131], v[140:143]
    v_mfma_f32_16x16x32_bf16 v[140:143], v[72:75], v[132:135], v[140:143]
    v_mfma_f32_16x16x32_bf16 v[140:143], v[76:79], v[136:139], v[140:143]
    v_mfma_f32_16x16x32_bf16 v[140:143], v[116:119], v[148:151], v[140:143]
    v_mfma_f32_16x16x32_bf16 v[140:143], v[112:115], v[156:159], v[140:143]
    v_mfma_f32_16x16x32_bf16 v[48:51], v[96:99], v[8:11], 0
    ds_read_b128 v[160:163], v45 offset:6144
    v_mfma_f32_16x16x32_bf16 v[60:63], v[96:99], v[32:35], 0
    ds_read2_b32 v[72:73], v4 offset0:48 offset1:49
    ds_read2_b32 v[74:75], v4 offset0:50 offset1:51
    v_mfma_f32_16x16x32_bf16 v[48:51], v[100:103], v[12:15], v[48:51]
    ds_read2_b32 v[76:77], v44 offset0:48 offset1:49
    ds_read2_b32 v[78:79], v44 offset0:50 offset1:51
    v_mfma_f32_16x16x32_bf16 v[60:63], v[100:103], v[36:39], v[60:63]
    v_mfma_f32_16x16x32_bf16 v[48:51], v[88:91], v[16:19], v[48:51]
    v_sub_f32 v56, v56, v140
    v_sub_f32 v57, v57, v141
    v_mfma_f32_16x16x32_bf16 v[60:63], v[88:91], v[40:43], v[60:63]
    v_sub_f32 v58, v58, v142
    v_sub_f32 v59, v59, v143
    v_mfma_f32_16x16x32_bf16 v[48:51], v[92:95], v[20:23], v[48:51]
    s_waitcnt lgkmcnt(11)
    v_fma_f32 v164, v56, v164, v140
    v_fma_f32 v165, v57, v165, v141
    v_mfma_f32_16x16x32_bf16 v[60:63], v[92:95], v[128:131], v[60:63]
    v_fma_f32 v166, v58, v166, v142
    v_fma_f32 v167, v59, v167, v143
    v_mfma_f32_16x16x32_bf16 v[48:51], v[80:83], v[24:27], v[48:51]
    v_mov_b32 v6, 13
    ds_write_b128 v5, v[164:167] offset:37056
    v_mfma_f32_16x16x32_bf16 v[60:63], v[80:83], v[132:135], v[60:63]
    ds_write_b32 v47, v6
    s_setprio 0
    v_mfma_f32_16x16x32_bf16 v[48:51], v[84:87], v[28:31], v[48:51]
    v_mfma_f32_16x16x32_bf16 v[60:63], v[84:87], v[136:139], v[60:63]
    v_mfma_f32_16x16x32_bf16 v[48:51], v[120:123], v[144:147], v[48:51]
    v_mfma_f32_16x16x32_bf16 v[60:63], v[120:123], v[148:151], v[60:63]
    v_mfma_f32_16x16x32_bf16 v[48:51], v[116:119], v[152:155], v[48:51]
    v_mfma_f32_16x16x32_bf16 v[60:63], v[116:119], v[156:159], v[60:63]
    s_waitcnt lgkmcnt(11)
    v_mfma_f32_16x16x32_bf16 v[48:51], v[112:115], v[64:67], v[48:51]
    s_waitcnt lgkmcnt(9)
    v_mfma_f32_16x16x32_bf16 v[60:63], v[112:115], v[68:71], v[60:63]
    v_mfma_f32_16x16x32_bf16 v[52:55], v[104:107], v[8:11], 0
    ds_read_b128 v[164:167], v45 offset:7168
    v_mfma_f32_16x16x32_bf16 v[140:143], v[104:107], v[32:35], 0
    v_mfma_f32_16x16x32_bf16 v[52:55], v[108:111], v[12:15], v[52:55]
    v_mfma_f32_16x16x32_bf16 v[140:143], v[108:111], v[36:39], v[140:143]
    v_mfma_f32_16x16x32_bf16 v[52:55], v[96:99], v[16:19], v[52:55]
    v_mfma_f32_16x16x32_bf16 v[140:143], v[96:99], v[40:43], v[140:143]
    v_mfma_f32_16x16x32_bf16 v[52:55], v[100:103], v[20:23], v[52:55]
    v_mfma_f32_16x16x32_bf16 v[140:143], v[100:103], v[128:131], v[140:143]
    v_sub_f32 v48, v48, v60
    v_sub_f32 v49, v49, v61
    v_mfma_f32_16x16x32_bf16 v[52:55], v[88:91], v[24:27], v[52:55]
    v_sub_f32 v50, v50, v62
    v_sub_f32 v51, v51, v63
    v_mfma_f32_16x16x32_bf16 v[140:143], v[88:91], v[132:135], v[140:143]
    s_waitcnt lgkmcnt(7)
    v_fma_f32 v160, v48, v160, v60
    v_fma_f32 v161, v49, v161, v61
    v_mfma_f32_16x16x32_bf16 v[52:55], v[92:95], v[28:31], v[52:55]
    v_fma_f32 v162, v50, v162, v62
    v_fma_f32 v163, v51, v163, v63
    v_mfma_f32_16x16x32_bf16 v[140:143], v[92:95], v[136:139], v[140:143]
    v_mov_b32 v6, 14
    ds_write_b128 v5, v[160:163] offset:49408
    v_mfma_f32_16x16x32_bf16 v[52:55], v[124:127], v[144:147], v[52:55]
    ds_write_b32 v47, v6
    v_mfma_f32_16x16x32_bf16 v[140:143], v[124:127], v[148:151], v[140:143]
    v_mfma_f32_16x16x32_bf16 v[52:55], v[120:123], v[152:155], v[52:55]
    v_mfma_f32_16x16x32_bf16 v[140:143], v[120:123], v[156:159], v[140:143]
    v_mfma_f32_16x16x32_bf16 v[52:55], v[116:119], v[64:67], v[52:55]
    v_mfma_f32_16x16x32_bf16 v[140:143], v[116:119], v[68:71], v[140:143]
    s_waitcnt lgkmcnt(7)
    v_mfma_f32_16x16x32_bf16 v[52:55], v[112:115], v[72:75], v[52:55]
    s_waitcnt lgkmcnt(5)
    v_mfma_f32_16x16x32_bf16 v[140:143], v[112:115], v[76:79], v[140:143]
    s_nop 7
    v_sub_f32 v52, v52, v140
    v_sub_f32 v53, v53, v141
    v_sub_f32 v54, v54, v142
    v_sub_f32 v55, v55, v143
    s_waitcnt lgkmcnt(2)
    v_fma_f32 v164, v52, v164, v140
    v_fma_f32 v165, v53, v165, v141
    v_fma_f32 v166, v54, v166, v142
    v_fma_f32 v167, v55, v167, v143
    v_mov_b32 v6, 15
    ds_write_b128 v5, v[164:167] offset:61760
    ds_write_b32 v47, v6
    s_branch FIN
HELPER:
    s_mov_b32 s60, s50
    s_mov_b32 s61, s51
    s_mov_b32 s62, 2621440
    s_mov_b32 s63, 0x20000
    v_lshrrev_b32 v20, 2, v0
    v_and_b32 v21, 3, v0
    v_lshl_add_u32 v22, v21, 2, v20
    v_and_b32 v22, 15, v22
    v_lshlrev_b32 v22, 4, v22
    s_mul_i32 s14, s7, 3088
    v_add_u32 v22, s14, v22
    v_lshl_add_u32 v23, v21, 10, v22
    v_add_u32 v23, 768, v23
    v_lshl_add_u32 v22, v21, 8, v22
    v_mul_u32_u24 v25, 5120, v20
    v_add_u32 v26, s6, v21
    v_lshl_add_u32 v25, v26, 1, v25
    v_lshl_add_u32 v26, v21, 2, 3
    v_and_b32 v27, 7, v0
    v_cmp_gt_u32 vcc, 8, v0
    s_nop 1
    v_cndmask_b32 v26, v26, v27, vcc
    v_lshlrev_b32 v26, 2, v26
    v_add_u32 v26, 131072, v26
    s_mov_b32 exec_lo, 0x77777777
    s_mov_b32 exec_hi, 0x77777777
    s_add_u32 s78, s7, 32
    s_mul_i32 s13, s7, 81920
    s_mov_b32 s14, 8
    s_movk_i32 s15, 0x777
    s_setprio 0
    s_mov_b32 s1, 0
POLL_14:
    ds_read_b32 v28, v26
    s_waitcnt lgkmcnt(0)
    v_cmp_le_u32 vcc, 6, v28
    s_andn2_b32 s12, 0x77, vcc_lo
    s_cbranch_scc0 POLL_14_X
    s_sleep 4
    s_add_u32 s1, s1, 1
    s_cmp_lt_u32 s1, 0x8000
    s_cbranch_scc1 POLL_14
POLL_14_X:
    s_setprio 3
HSLOW:
    s_mov_b32 s1, 0
POLL_15:
    ds_read_b32 v28, v26
    s_waitcnt lgkmcnt(0)
    v_cmp_le_u32 vcc, s14, v28
    s_andn2_b32 s12, s15, vcc_lo
    s_cbranch_scc0 POLL_15_X
    s_sleep 1
    s_add_u32 s1, s1, 1
    s_cmp_lt_u32 s1, 0x8000
    s_cbranch_scc1 POLL_15
POLL_15_X:
    ds_read_b128 v[12:15], v22
    ds_read_b128 v[16:19], v22 offset:1024
    ds_read_b128 v[32:35], v23
HGO:
    v_add_u32 v22, 9264, v22
    v_add_u32 v23, 9264, v23
    s_cmp_lt_u32 s78, 40
    s_waitcnt lgkmcnt(1)
    v_add_f32 v8, v12, v16
    v_add_f32 v9, v13, v17
    v_add_f32 v10, v14, v18
    v_add_f32 v11, v15, v19
    s_waitcnt lgkmcnt(0)
    s_cbranch_scc1 HNOT
    v_add_f32 v8, v8, v32
    v_add_f32 v9, v9, v33
    v_add_f32 v10, v10, v34
    v_add_f32 v11, v11, v35
HNOT:
    ds_read_b32 v28, v26
    ds_read_b128 v[12:15], v22
    ds_read_b128 v[16:19], v22 offset:1024
    ds_read_b128 v[32:35], v23
    v_cvt_pk_bf16_f32 v36, v8, v9
    v_cvt_pk_bf16_f32 v37, v10, v11
    s_add_u32 s78, s78, 3
    s_lshr_b32 s14, s78, 2
    buffer_store_short v36, v25, s[60:63], s13 offen
    buffer_store_short_d16_hi v36, v25, s[60:63], s13 offen offset:1280
    buffer_store_short v37, v25, s[60:63], s13 offen offset:2560
    buffer_store_short_d16_hi v37, v25, s[60:63], s13 offen offset:3840
    s_add_u32 s13, s13, 245760
    s_waitcnt lgkmcnt(3)
    v_cmp_le_u32 vcc, s14, v28
    s_andn2_b32 s12, s15, vcc_lo
    s_cbranch_scc0 HGO
    s_cmp_lt_u32 s78, 64
    s_cbranch_scc1 HSLOW
FIN:
END:
    s_endpgm
KG_SLOW:
    v_mov_b32 v43, 0x3f80
    ds_write_addtid_b32 v43 offset:0
    v_cvt_pk_bf16_f32 v40, v24, v25
    ds_write_addtid_b32 v40 offset:3088
    v_pk_mul_f32 v[28:29], v[24:25], v[24:25] op_sel_hi:[1,0]
    v_pk_fma_f32 v[26:27], v[24:25], v[24:25], v[28:29] op_sel:[1,1,0] op_sel_hi:[0,1,1] neg_lo:[1,0,0]
    v_cvt_pk_bf16_f32 v41, v26, v27
    ds_write_addtid_b32 v41 offset:6176
    v_pk_mul_f32 v[28:29], v[26:27], v[24:25] op_sel_hi:[1,0]
    v_pk_fma_f32 v[26:27], v[26:27], v[24:25], v[28:29] op_sel:[1,1,0] op_sel_hi:[0,1,1] neg_lo:[1,0,0]
    v_cvt_pk_bf16_f32 v42, v26, v27
    ds_write_addtid_b32 v42 offset:9264
    v_pk_mul_f32 v[28:29], v[26:27], v[24:25] op_sel_hi:[1,0]
    v_pk_fma_f32 v[26:27], v[26:27], v[24:25], v[28:29] op_sel:[1,1,0] op_sel_hi:[0,1,1] neg_lo:[1,0,0]
    v_cvt_pk_bf16_f32 v43, v26, v27
    ds_write_addtid_b32 v43 offset:12352
    v_pk_mul_f32 v[28:29], v[26:27], v[24:25] op_sel_hi:[1,0]
    v_pk_fma_f32 v[26:27], v[26:27], v[24:25], v[28:29] op_sel:[1,1,0] op_sel_hi:[0,1,1] neg_lo:[1,0,0]
    v_cvt_pk_bf16_f32 v40, v26, v27
    ds_write_addtid_b32 v40 offset:15440
    v_pk_mul_f32 v[28:29], v[26:27], v[24:25] op_sel_hi:[1,0]
    v_pk_fma_f32 v[26:27], v[26:27], v[24:25], v[28:29] op_sel:[1,1,0] op_sel_hi:[0,1,1] neg_lo:[1,0,0]
    v_cvt_pk_bf16_f32 v41, v26, v27
    ds_write_addtid_b32 v41 offset:18528
    v_pk_mul_f32 v[28:29], v[26:27], v[24:25] op_sel_hi:[1,0]
    v_pk_fma_f32 v[26:27], v[26:27], v[24:25], v[28:29] op_sel:[1,1,0] op_sel_hi:[0,1,1] neg_lo:[1,0,0]
    v_cvt_pk_bf16_f32 v42, v26, v27
    ds_write_addtid_b32 v42 offset:21616
    v_pk_mul_f32 v[28:29], v[26:27], v[24:25] op_sel_hi:[1,0]
    v_pk_fma_f32 v[26:27], v[26:27], v[24:25], v[28:29] op_sel:[1,1,0] op_sel_hi:[0,1,1] neg_lo:[1,0,0]
    v_cvt_pk_bf16_f32 v43, v26, v27
    ds_write_addtid_b32 v43 offset:24704
    v_pk_mul_f32 v[28:29], v[26:27], v[24:25] op_sel_hi:[1,0]
    v_pk_fma_f32 v[26:27], v[26:27], v[24:25], v[28:29] op_sel:[1,1,0] op_sel_hi:[0,1,1] neg_lo:[1,0,0]
    v_cvt_pk_bf16_f32 v40, v26, v27
    ds_write_addtid_b32 v40 offset:27792
    v_pk_mul_f32 v[28:29], v[26:27], v[24:25] op_sel_hi:[1,0]
    v_pk_fma_f32 v[26:27], v[26:27], v[24:25], v[28:29] op_sel:[1,1,0] op_sel_hi:[0,1,1] neg_lo:[1,0,0]
    v_cvt_pk_bf16_f32 v41, v26, v27
    ds_write_addtid_b32 v41 offset:30880
    v_pk_mul_f32 v[28:29], v[26:27], v[24:25] op_sel_hi:[1,0]
    v_pk_fma_f32 v[26:27], v[26:27], v[24:25], v[28:29] op_sel:[1,1,0] op_sel_hi:[0,1,1] neg_lo:[1,0,0]
    v_cvt_pk_bf16_f32 v42, v26, v27
    ds_write_addtid_b32 v42 offset:33968
    v_pk_mul_f32 v[28:29], v[26:27], v[24:25] op_sel_hi:[1,0]
    v_pk_fma_f32 v[26:27], v[26:27], v[24:25], v[28:29] op_sel:[1,1,0] op_sel_hi:[0,1,1] neg_lo:[1,0,0]
    v_cvt_pk_bf16_f32 v43, v26, v27
    ds_write_addtid_b32 v43 offset:37056
    v_pk_mul_f32 v[28:29], v[26:27], v[24:25] op_sel_hi:[1,0]
    v_pk_fma_f32 v[26:27], v[26:27], v[24:25], v[28:29] op_sel:[1,1,0] op_sel_hi:[0,1,1] neg_lo:[1,0,0]
    v_cvt_pk_bf16_f32 v40, v26, v27
    ds_write_addtid_b32 v40 offset:40144
    v_pk_mul_f32 v[28:29], v[26:27], v[24:25] op_sel_hi:[1,0]
    v_pk_fma_f32 v[26:27], v[26:27], v[24:25], v[28:29] op_sel:[1,1,0] op_sel_hi:[0,1,1] neg_lo:[1,0,0]
    v_cvt_pk_bf16_f32 v41, v26, v27
    ds_write_addtid_b32 v41 offset:43232
    v_pk_mul_f32 v[28:29], v[26:27], v[24:25] op_sel_hi:[1,0]
    v_pk_fma_f32 v[26:27], v[26:27], v[24:25], v[28:29] op_sel:[1,1,0] op_sel_hi:[0,1,1] neg_lo:[1,0,0]
    v_cvt_pk_bf16_f32 v42, v26, v27
    ds_write_addtid_b32 v42 offset:46320
    s_mov_b32 m0, s77
    v_pk_mul_f32 v[28:29], v[26:27], v[24:25] op_sel_hi:[1,0]
    v_pk_fma_f32 v[26:27], v[26:27], v[24:25], v[28:29] op_sel:[1,1,0] op_sel_hi:[0,1,1] neg_lo:[1,0,0]
    v_cvt_pk_bf16_f32 v43, v26, v27
    ds_write_addtid_b32 v43 offset:15440
    v_pk_mul_f32 v[28:29], v[26:27], v[24:25] op_sel_hi:[1,0]
    v_pk_fma_f32 v[26:27], v[26:27], v[24:25], v[28:29] op_sel:[1,1,0] op_sel_hi:[0,1,1] neg_lo:[1,0,0]
    v_cvt_pk_bf16_f32 v40, v26, v27
    ds_write_addtid_b32 v40 offset:18528
    v_pk_mul_f32 v[28:29], v[26:27], v[24:25] op_sel_hi:[1,0]
    v_pk_fma_f32 v[26:27], v[26:27], v[24:25], v[28:29] op_sel:[1,1,0] op_sel_hi:[0,1,1] neg_lo:[1,0,0]
    v_cvt_pk_bf16_f32 v41, v26, v27
    ds_write_addtid_b32 v41 offset:21616
    v_pk_mul_f32 v[28:29], v[26:27], v[24:25] op_sel_hi:[1,0]
    v_pk_fma_f32 v[26:27], v[26:27], v[24:25], v[28:29] op_sel:[1,1,0] op_sel_hi:[0,1,1] neg_lo:[1,0,0]
    v_cvt_pk_bf16_f32 v42, v26, v27
    ds_write_addtid_b32 v42 offset:24704
    v_pk_mul_f32 v[28:29], v[26:27], v[24:25] op_sel_hi:[1,0]
    v_pk_fma_f32 v[26:27], v[26:27], v[24:25], v[28:29] op_sel:[1,1,0] op_sel_hi:[0,1,1] neg_lo:[1,0,0]
    v_cvt_pk_bf16_f32 v43, v26, v27
    ds_write_addtid_b32 v43 offset:27792
    v_pk_mul_f32 v[28:29], v[26:27], v[24:25] op_sel_hi:[1,0]
    v_pk_fma_f32 v[26:27], v[26:27], v[24:25], v[28:29] op_sel:[1,1,0] op_sel_hi:[0,1,1] neg_lo:[1,0,0]
    v_cvt_pk_bf16_f32 v40, v26, v27
    ds_write_addtid_b32 v40 offset:30880
    v_pk_mul_f32 v[28:29], v[26:27], v[24:25] op_sel_hi:[1,0]
    v_pk_fma_f32 v[26:27], v[26:27], v[24:25], v[28:29] op_sel:[1,1,0] op_sel_hi:[0,1,1] neg_lo:[1,0,0]
    v_cvt_pk_bf16_f32 v41, v26, v27
    ds_write_addtid_b32 v41 offset:33968
    v_pk_mul_f32 v[28:29], v[26:27], v[24:25] op_sel_hi:[1,0]
    v_pk_fma_f32 v[26:27], v[26:27], v[24:25], v[28:29] op_sel:[1,1,0] op_sel_hi:[0,1,1] neg_lo:[1,0,0]
    v_cvt_pk_bf16_f32 v42, v26, v27
    ds_write_addtid_b32 v42 offset:37056
    v_pk_mul_f32 v[28:29], v[26:27], v[24:25] op_sel_hi:[1,0]
    v_pk_fma_f32 v[26:27], v[26:27], v[24:25], v[28:29] op_sel:[1,1,0] op_sel_hi:[0,1,1] neg_lo:[1,0,0]
    v_cvt_pk_bf16_f32 v43, v26, v27
    ds_write_addtid_b32 v43 offset:40144
    v_pk_mul_f32 v[28:29], v[26:27], v[24:25] op_sel_hi:[1,0]
    v_pk_fma_f32 v[26:27], v[26:27], v[24:25], v[28:29] op_sel:[1,1,0] op_sel_hi:[0,1,1] neg_lo:[1,0,0]
    v_cvt_pk_bf16_f32 v40, v26, v27
    ds_write_addtid_b32 v40 offset:43232
    v_pk_mul_f32 v[28:29], v[26:27], v[24:25] op_sel_hi:[1,0]
    v_pk_fma_f32 v[26:27], v[26:27], v[24:25], v[28:29] op_sel:[1,1,0] op_sel_hi:[0,1,1] neg_lo:[1,0,0]
    v_cvt_pk_bf16_f32 v41, v26, v27
    ds_write_addtid_b32 v41 offset:46320
    v_pk_mul_f32 v[28:29], v[26:27], v[24:25] op_sel_hi:[1,0]
    v_pk_fma_f32 v[26:27], v[26:27], v[24:25], v[28:29] op_sel:[1,1,0] op_sel_hi:[0,1,1] neg_lo:[1,0,0]
    v_cvt_pk_bf16_f32 v42, v26, v27
    ds_write_addtid_b32 v42 offset:49408
    v_pk_mul_f32 v[28:29], v[26:27], v[24:25] op_sel_hi:[1,0]
    v_pk_fma_f32 v[26:27], v[26:27], v[24:25], v[28:29] op_sel:[1,1,0] op_sel_hi:[0,1,1] neg_lo:[1,0,0]
    v_cvt_pk_bf16_f32 v43, v26, v27
    ds_write_addtid_b32 v43 offset:52496
    v_pk_mul_f32 v[28:29], v[26:27], v[24:25] op_sel_hi:[1,0]
    v_pk_fma_f32 v[26:27], v[26:27], v[24:25], v[28:29] op_sel:[1,1,0] op_sel_hi:[0,1,1] neg_lo:[1,0,0]
    v_cvt_pk_bf16_f32 v40, v26, v27
    ds_write_addtid_b32 v40 offset:55584
    v_pk_mul_f32 v[28:29], v[26:27], v[24:25] op_sel_hi:[1,0]
    v_pk_fma_f32 v[26:27], v[26:27], v[24:25], v[28:29] op_sel:[1,1,0] op_sel_hi:[0,1,1] neg_lo:[1,0,0]
    v_cvt_pk_bf16_f32 v41, v26, v27
    ds_write_addtid_b32 v41 offset:58672
    v_pk_mul_f32 v[28:29], v[26:27], v[24:25] op_sel_hi:[1,0]
    v_pk_fma_f32 v[26:27], v[26:27], v[24:25], v[28:29] op_sel:[1,1,0] op_sel_hi:[0,1,1] neg_lo:[1,0,0]
    v_cvt_pk_bf16_f32 v42, v26, v27
    ds_write_addtid_b32 v42 offset:61760
    v_pk_mul_f32 v[28:29], v[26:27], v[24:25] op_sel_hi:[1,0]
    v_pk_fma_f32 v[26:27], v[26:27], v[24:25], v[28:29] op_sel:[1,1,0] op_sel_hi:[0,1,1] neg_lo:[1,0,0]
    ds_read_b128 v[64:67], v44 offset:0
    ds_read_b128 v[68:71], v44 offset:32
    ds_read_b128 v[72:75], v44 offset:64
    ds_read_b128 v[76:79], v44 offset:96
    ds_read_b128 v[80:83], v44 offset:128
    ds_read_b128 v[84:87], v44 offset:160
    ds_read_b128 v[88:91], v44 offset:192
    ds_read_b128 v[92:95], v44 offset:224
    s_mov_b32 m0, s76
    v_mov_b32 v29, 0x3c00
    ds_write_addtid_b32 v29 offset:0
    v_cvt_pk_bf16_f32 v43, v30, -v31
    ds_write_addtid_b32 v43 offset:3088
    v_pk_mul_f32 v[28:29], v[30:31], v[22:23] op_sel_hi:[1,0]
    v_pk_fma_f32 v[30:31], v[30:31], v[22:23], v[28:29] op_sel:[1,1,0] op_sel_hi:[0,1,1] neg_lo:[1,0,0]
    v_cvt_pk_bf16_f32 v40, v30, -v31
    ds_write_addtid_b32 v40 offset:24704
    v_pk_mul_f32 v[28:29], v[30:31], v[22:23] op_sel_hi:[1,0]
    v_pk_fma_f32 v[32:33], v[30:31], v[22:23], v[28:29] op_sel:[1,1,0] op_sel_hi:[0,1,1] neg_lo:[1,0,0]
    v_cvt_pk_bf16_f32 v41, v32, -v33
    ds_write_addtid_b32 v41 offset:27792
    v_pk_mul_f32 v[28:29], v[32:33], v[22:23] op_sel_hi:[1,0]
    v_pk_fma_f32 v[30:31], v[32:33], v[22:23], v[28:29] op_sel:[1,1,0] op_sel_hi:[0,1,1] neg_lo:[1,0,0]
    v_cvt_pk_bf16_f32 v42, v30, -v31
    ds_write_addtid_b32 v42 offset:30880
    v_pk_mul_f32 v[28:29], v[30:31], v[22:23] op_sel_hi:[1,0]
    v_pk_fma_f32 v[34:35], v[30:31], v[22:23], v[28:29] op_sel:[1,1,0] op_sel_hi:[0,1,1] neg_lo:[1,0,0]
    v_cvt_pk_bf16_f32 v43, v34, -v35
    ds_write_addtid_b32 v43 offset:33968
    v_pk_mul_f32 v[28:29], v[34:35], v[22:23] op_sel_hi:[1,0]
    v_pk_fma_f32 v[30:31], v[34:35], v[22:23], v[28:29] op_sel:[1,1,0] op_sel_hi:[0,1,1] neg_lo:[1,0,0]
    v_cvt_pk_bf16_f32 v40, v30, -v31
    ds_write_addtid_b32 v40 offset:49408
    v_pk_mul_f32 v[28:29], v[30:31], v[22:23] op_sel_hi:[1,0]
    v_pk_fma_f32 v[36:37], v[30:31], v[22:23], v[28:29] op_sel:[1,1,0] op_sel_hi:[0,1,1] neg_lo:[1,0,0]
    v_cvt_pk_bf16_f32 v41, v36, -v37
    ds_write_addtid_b32 v41 offset:52496
    v_pk_mul_f32 v[28:29], v[36:37], v[22:23] op_sel_hi:[1,0]
    v_pk_fma_f32 v[30:31], v[36:37], v[22:23], v[28:29] op_sel:[1,1,0] op_sel_hi:[0,1,1] neg_lo:[1,0,0]
    v_cvt_pk_bf16_f32 v42, v30, -v31
    ds_write_addtid_b32 v42 offset:55584
    v_pk_mul_f32 v[28:29], v[30:31], v[22:23] op_sel_hi:[1,0]
    v_pk_fma_f32 v[38:39], v[30:31], v[22:23], v[28:29] op_sel:[1,1,0] op_sel_hi:[0,1,1] neg_lo:[1,0,0]
    v_cvt_pk_bf16_f32 v43, v38, -v39
    ds_write_addtid_b32 v43 offset:58672
    s_mov_b32 m0, s77
    v_pk_mul_f32 v[28:29], v[32:33], v[26:27] op_sel_hi:[1,0]
    v_pk_fma_f32 v[32:33], v[32:33], v[26:27], v[28:29] op_sel:[1,1,0] op_sel_hi:[0,1,1] neg_lo:[1,0,0]
    v_cvt_pk_bf16_f32 v40, v32, -v33
    ds_write_addtid_b32 v40 offset:6176
    v_pk_mul_f32 v[28:29], v[34:35], v[26:27] op_sel_hi:[1,0]
    v_pk_fma_f32 v[34:35], v[34:35], v[26:27], v[28:29] op_sel:[1,1,0] op_sel_hi:[0,1,1] neg_lo:[1,0,0]
    v_cvt_pk_bf16_f32 v41, v34, -v35
    ds_write_addtid_b32 v41 offset:9264
    v_pk_mul_f32 v[28:29], v[36:37], v[26:27] op_sel_hi:[1,0]
    v_pk_fma_f32 v[36:37], v[36:37], v[26:27], v[28:29] op_sel:[1,1,0] op_sel_hi:[0,1,1] neg_lo:[1,0,0]
    v_cvt_pk_bf16_f32 v42, v36, -v37
    ds_write_addtid_b32 v42 offset:30880
    v_pk_mul_f32 v[28:29], v[38:39], v[26:27] op_sel_hi:[1,0]
    v_pk_fma_f32 v[38:39], v[38:39], v[26:27], v[28:29] op_sel:[1,1,0] op_sel_hi:[0,1,1] neg_lo:[1,0,0]
    v_cvt_pk_bf16_f32 v43, v38, -v39
    ds_write_addtid_b32 v43 offset:37056
    v_pk_mul_f32 v[28:29], v[34:35], v[26:27] op_sel_hi:[1,0]
    v_pk_fma_f32 v[34:35], v[34:35], v[26:27], v[28:29] op_sel:[1,1,0] op_sel_hi:[0,1,1] neg_lo:[1,0,0]
    v_cvt_pk_bf16_f32 v40, v34, -v35
    ds_write_addtid_b32 v40 offset:40144
    v_pk_mul_f32 v[28:29], v[38:39], v[26:27] op_sel_hi:[1,0]
    v_pk_fma_f32 v[38:39], v[38:39], v[26:27], v[28:29] op_sel:[1,1,0] op_sel_hi:[0,1,1] neg_lo:[1,0,0]
    v_cvt_pk_bf16_f32 v41, v38, -v39
    ds_write_addtid_b32 v41 offset:43232
    v_pk_mul_f32 v[28:29], v[34:35], v[26:27] op_sel_hi:[1,0]
    v_pk_fma_f32 v[34:35], v[34:35], v[26:27], v[28:29] op_sel:[1,1,0] op_sel_hi:[0,1,1] neg_lo:[1,0,0]
    v_cvt_pk_bf16_f32 v42, v34, -v35
    ds_write_addtid_b32 v42 offset:52496
    v_pk_mul_f32 v[28:29], v[38:39], v[26:27] op_sel_hi:[1,0]
    v_pk_fma_f32 v[38:39], v[38:39], v[26:27], v[28:29] op_sel:[1,1,0] op_sel_hi:[0,1,1] neg_lo:[1,0,0]
    v_cvt_pk_bf16_f32 v43, v38, -v39
    ds_write_addtid_b32 v43 offset:55584
    v_pk_mul_f32 v[28:29], v[38:39], v[26:27] op_sel_hi:[1,0]
    v_pk_fma_f32 v[38:39], v[38:39], v[26:27], v[28:29] op_sel:[1,1,0] op_sel_hi:[0,1,1] neg_lo:[1,0,0]
    v_cvt_pk_bf16_f32 v40, v38, -v39
    ds_write_addtid_b32 v40 offset:46320
    v_pk_mul_f32 v[28:29], v[38:39], v[26:27] op_sel_hi:[1,0]
    v_pk_fma_f32 v[38:39], v[38:39], v[26:27], v[28:29] op_sel:[1,1,0] op_sel_hi:[0,1,1] neg_lo:[1,0,0]
    v_cvt_pk_bf16_f32 v41, v38, -v39
    ds_write_addtid_b32 v41 offset:58672
    v_pk_mul_f32 v[28:29], v[38:39], v[26:27] op_sel_hi:[1,0]
    v_pk_fma_f32 v[38:39], v[38:39], v[26:27], v[28:29] op_sel:[1,1,0] op_sel_hi:[0,1,1] neg_lo:[1,0,0]
    v_cvt_pk_bf16_f32 v42, v38, -v39
    ds_write_addtid_b32 v42 offset:49408
    v_pk_mul_f32 v[28:29], v[38:39], v[26:27] op_sel_hi:[1,0]
    v_pk_fma_f32 v[38:39], v[38:39], v[26:27], v[28:29] op_sel:[1,1,0] op_sel_hi:[0,1,1] neg_lo:[1,0,0]
    v_cvt_pk_bf16_f32 v43, v38, -v39
    ds_write_addtid_b32 v43 offset:61760
    s_cmp_lg_u32 s78, 1
    s_cbranch_scc1 KG_NPS
    ds_read_b32 v28, v46
    ds_read_b128 v[128:131], v147 offset:0
    ds_read_b128 v[132:135], v147 offset:12352
    ds_read_b128 v[136:139], v147 offset:24704
    ds_read_b128 v[140:143], v147 offset:37056
KG_NPS:
    ds_read_b128 v[96:99], v44 offset:0
    ds_read_b128 v[100:103], v44 offset:32
    ds_read_b128 v[104:107], v44 offset:64
    ds_read_b128 v[108:111], v44 offset:96
    ds_read_b128 v[112:115], v44 offset:128
    ds_read_b128 v[116:119], v44 offset:160
    ds_read_b128 v[120:123], v44 offset:192
    ds_read_b128 v[124:127], v44 offset:224
    s_waitcnt vmcnt(0)
    v_mov_b32 v2, v8
    v_mov_b32 v3, v9
    v_mov_b32 v4, v10
    v_mov_b32 v5, v11
    v_mov_b32 v6, v12
    v_mov_b32 v7, v13
    s_waitcnt lgkmcnt(6)
    v_mfma_f32_32x32x16_bf16 v[48:63], v[96:99], v[64:67], v[48:63]
    s_waitcnt lgkmcnt(4)
    v_mfma_f32_32x32x16_bf16 v[48:63], v[100:103], v[68:71], v[48:63]
    s_waitcnt lgkmcnt(2)
    v_mfma_f32_32x32x16_bf16 v[48:63], v[104:107], v[72:75], v[48:63]
    s_waitcnt lgkmcnt(0)
    v_mfma_f32_32x32x16_bf16 v[48:63], v[108:111], v[76:79], v[48:63]
    v_mfma_f32_32x32x16_bf16 v[48:63], v[112:115], v[80:83], v[48:63]
    v_mfma_f32_32x32x16_bf16 v[48:63], v[116:119], v[84:87], v[48:63]
    v_mfma_f32_32x32x16_bf16 v[48:63], v[120:123], v[88:91], v[48:63]
    v_mfma_f32_32x32x16_bf16 v[48:63], v[124:127], v[92:95], v[48:63]
    s_branch KG_JOIN
.section .rodata,"a"
.p2align 6
.amdhsa_kernel gated_mix__ssm_conv_s4__ssm_conv_s4d__prompt_kernel
  .amdhsa_next_free_vgpr 168
  .amdhsa_next_free_sgpr 102
  .amdhsa_accum_offset 168
  .amdhsa_group_segment_fixed_size 0
  .amdhsa_kernarg_size 160
  .amdhsa_user_sgpr_count 2
  .amdhsa_user_sgpr_kernarg_segment_ptr 1
  .amdhsa_system_sgpr_workgroup_id_x 1
.end_amdhsa_kernel
```
